```python
import torch

def _softmax(x, axis=-1):
    return torch.softmax(x, dim=axis)
def _gelu(x):
    return torch.nn.functional.gelu(x, approximate="tanh")
def _silu(x):
    return torch.nn.functional.silu(x)
def _sigmoid(x):
    return torch.sigmoid(x)
def _layernorm(x, axis=-1, eps=1e-5):
    m = x.mean(dim=axis, keepdim=True)
    v = x.var(dim=axis, keepdim=True, unbiased=False)
    return (x - m) / torch.sqrt(v + eps)
def _scatter_add(tgt, idx, src, axis=0):
    return tgt.clone().index_add_(axis, idx, src)
def _segment_sum(src, seg, n):
    out = torch.zeros((n,) + src.shape[1:], dtype=src.dtype)
    return out.index_add_(0, seg, src)
def _pad(x, pw):
    flat = tuple(v for pair in reversed(pw) for v in pair)
    return torch.nn.functional.pad(x, flat)

kernel_name = 'recurrent_scan__mha_block_cached__geglu_ffn__decode'

def setup_inputs():

    _w = (lambda a: (lambda t: t.to(torch.bfloat16) if t.is_floating_point() else t)(torch.as_tensor(a)))
    def _A_setup():
        B, Sq, D = 2, 1, 512
        H, Sk, Dh = 32, 8192, 128
        return {
            "x": _w((lambda *s: torch.randn(*s, dtype=torch.bfloat16) * 0.05)(B, Sq, D)),
            "k_cache": _w((lambda *s: torch.randn(*s, dtype=torch.bfloat16) * 1.6)(B, H, Sk, Dh)),
            "v_cache": _w((lambda *s: torch.randn(*s, dtype=torch.bfloat16) * 0.2)(B, H, Sk, Dh)),
            "wq": _w((lambda *s: torch.randn(*s, dtype=torch.bfloat16) * 1.6)(D, H * Dh) * (D ** -0.5)),
            "wo": _w((lambda *s: torch.randn(*s, dtype=torch.bfloat16) * 0.2)(H * Dh, D) * ((H * Dh) ** -0.5)),
        }
    _A_in = _A_setup()

    def _B_setup():
        B, S, D, F = 2, 1, 512, 1376
        return {
            "x": _w((lambda *s: torch.randn(*s, dtype=torch.bfloat16) * 0.05)(B, S, D)),
            "w_gate": _w((lambda *s: torch.randn(*s, dtype=torch.bfloat16) * 0.1)(D, F)),
            "w_up": _w((lambda *s: torch.randn(*s, dtype=torch.bfloat16) * 0.1)(D, F)),
            "w_down": _w((lambda *s: torch.randn(*s, dtype=torch.bfloat16) * 0.1)(F, D)),
        }
    _B_in = _B_setup()

    return {
        "A_x": _A_in["x"],
        "A_k_cache": _A_in["k_cache"],
        "A_v_cache": _A_in["v_cache"],
        "A_wq": _A_in["wq"],
        "A_wo": _A_in["wo"],
        "B_x": _B_in["x"],
        "B_w_gate": _B_in["w_gate"],
        "B_w_up": _B_in["w_up"],
        "B_w_down": _B_in["w_down"],
    }

def reference(A_x, A_k_cache, A_v_cache, A_wq, A_wo, B_x, B_w_gate, B_w_up, B_w_down):
    def _A_ref(x, k_cache, v_cache, wq, wo):
        B, Sq, D = x.shape
        H, Dh = 32, 128
        q = (lambda x, *d: x.permute(*d))((x @ wq).reshape(B, Sq, H, Dh), 0, 2, 1, 3)
        scores = torch.einsum("bhqd,bhkd->bhqk", q, k_cache) * (Dh ** -0.5)
        p = _softmax(scores, axis=-1)
        o = torch.einsum("bhqk,bhkd->bhqd", p, v_cache)
        return (lambda x, *d: x.permute(*d))(o, 0, 2, 1, 3).reshape(B, Sq, H * Dh) @ wo

    def _B_ref(x, w_gate, w_up, w_down):
        return (_gelu(x @ w_gate) * (x @ w_up)) @ w_down

    x = A_x
    xn = _layernorm(x, axis=-1)
    s = _A_ref(xn, A_k_cache, A_v_cache, A_wq, A_wo)
    g = _silu(_B_ref(xn, B_w_gate, B_w_up, B_w_down))
    return x + s * g
```

```asm
; @launch grid=(256,1,1) block=(384,1,1) lds=81920
.amdgcn_target "amdgcn-amd-amdhsa--gfx950"
.text
.globl recurrent_scan__mha_block_cached__geglu_ffn__decode_kernel
.p2align 8
.type recurrent_scan__mha_block_cached__geglu_ffn__decode_kernel,@function
recurrent_scan__mha_block_cached__geglu_ffn__decode_kernel:
    s_cmp_ge_u32 s2, 256
    s_cbranch_scc1 L_end
    s_load_dwordx16 s[4:19], s[0:1], 0
    s_load_dwordx8 s[20:27], s[0:1], 64
    v_lshrrev_b32 v2, 6, v0
    v_and_b32 v1, 63, v0
    v_readfirstlane_b32 s3, v2
    v_and_b32 v2, 15, v1
    v_lshrrev_b32 v3, 4, v1
    s_bfe_u32 s28, s2, 0x50002
    s_lshr_b32 s29, s2, 7
    s_and_b32 s30, s2, 3
    s_lshl_b32 s32, s29, 2
    s_add_u32 s32, s32, s30
    s_lshl_b32 s31, s28, 3
    s_add_u32 s31, s31, s32
    s_mov_b32 s33, 0x3fb8aa3b
    s_cmp_eq_u32 s3, 0
    s_cbranch_scc1 L_A0
    s_cmp_eq_u32 s3, 1
    s_cbranch_scc1 L_A1
L_S:
    s_getpc_b64 s[56:57]
L_pc:
    s_sub_u32 s56, s56, L_pc-recurrent_scan__mha_block_cached__geglu_ffn__decode_kernel
    s_subb_u32 s57, s57, 0
    v_subrev_u32 v8, 128, v0
    v_lshlrev_b32 v8, 4, v8
    v_min_u32 v9, L_codeend-recurrent_scan__mha_block_cached__geglu_ffn__decode_kernel-16, v8
    global_load_dwordx4 v[200:203], v9, s[56:57]
    v_add_u32 v8, 4096, v8
    v_min_u32 v9, L_codeend-recurrent_scan__mha_block_cached__geglu_ffn__decode_kernel-16, v8
    global_load_dwordx4 v[204:207], v9, s[56:57]
    v_add_u32 v8, 4096, v8
    v_min_u32 v9, L_codeend-recurrent_scan__mha_block_cached__geglu_ffn__decode_kernel-16, v8
    global_load_dwordx4 v[208:211], v9, s[56:57]
    v_add_u32 v8, 4096, v8
    v_min_u32 v9, L_codeend-recurrent_scan__mha_block_cached__geglu_ffn__decode_kernel-16, v8
    global_load_dwordx4 v[212:215], v9, s[56:57]
    v_add_u32 v8, 4096, v8
    v_and_b32 v8, 3, v1
    v_lshlrev_b32 v15, 4, v8
    v_bfe_u32 v8, v1, 2, 2
    v_lshl_add_u32 v15, v8, 8, v15
    v_lshl_add_u32 v15, v3, 6, v15
    v_lshlrev_b32 v16, 4, v1
    s_lshl_b32 s56, s29, 5
    s_add_u32 s56, s56, s28
    s_lshl_b32 s63, s56, 21
    s_lshl_b32 s56, s30, 2
    s_add_u32 s56, s56, s3
    s_sub_u32 s56, s56, 2
    s_lshl_b32 s56, s56, 12
    s_add_u32 s63, s63, s56
    s_waitcnt lgkmcnt(0)
    s_mov_b32 s36, s6
    s_and_b32 s37, s7, 0xffff
    s_mov_b32 s38, 0x8000000
    s_mov_b32 s39, 0x20000
    s_mov_b32 s40, s8
    s_and_b32 s41, s9, 0xffff
    s_mov_b32 s42, 0x8000000
    s_mov_b32 s43, 0x20000
    s_mov_b32 s44, s6
    s_and_b32 s45, s7, 0xffff
    s_mov_b32 s46, 0x8000000
    s_mov_b32 s47, 0x20000
    s_mov_b32 s86, s63
    s_sub_u32 s60, s3, 2
    s_mul_i32 s61, s60, 16384
    s_add_u32 s61, s61, 16384
    v_add_u32 v19, s61, v16
    v_mov_b32 v117, v15
    s_barrier
    buffer_load_dwordx4 v[52:55], v15, s[36:39], s63 offen offset:0 nt
    buffer_load_dwordx4 v[56:59], v15, s[36:39], s63 offen offset:1024 nt
    buffer_load_dwordx4 v[60:63], v15, s[36:39], s63 offen offset:2048 nt
    buffer_load_dwordx4 v[64:67], v15, s[36:39], s63 offen offset:3072 nt
    s_add_u32 s63, s63, 0x10000
    v_and_b32 v8, 1, v1
    v_lshlrev_b32 v8, 4, v8
    v_mov_b32 v9, 0xffff
    v_lshlrev_b32 v9, v8, v9
    v_bfe_u32 v8, v1, 1, 2
    v_cmp_eq_u32 vcc, 0, v8
    s_nop 1
    v_cndmask_b32 v4, 0, v9, vcc
    v_cmp_eq_u32 vcc, 1, v8
    s_nop 1
    v_cndmask_b32 v5, 0, v9, vcc
    v_cmp_eq_u32 vcc, 2, v8
    s_nop 1
    v_cndmask_b32 v6, 0, v9, vcc
    v_cmp_eq_u32 vcc, 3, v8
    s_nop 1
    v_cndmask_b32 v7, 0, v9, vcc
    s_lshr_b32 s67, s31, 2
    s_mul_i32 s67, s67, 512
    s_add_u32 s67, s67, 0x150000
    s_mov_b32 s69, 0
    s_mov_b32 s68, -1
    s_lshl_b32 s56, s29, 5
    s_add_u32 s56, s56, s28
    s_lshl_b32 s90, s56, 21
    s_add_u32 s90, s90, 1703936
    v_mov_b32 v24, 0
    v_mov_b32 v25, 0
    v_mov_b32 v26, 0
    v_mov_b32 v27, 0
    v_mov_b32 v14, 0
    v_mov_b32 v12, 0xff800000
    v_and_b32 v8, 3, v2
    v_lshl_add_u32 v8, v3, 2, v8
    v_lshlrev_b32 v17, 4, v8
    v_lshrrev_b32 v18, 2, v2
    v_lshlrev_b32 v240, 3, v3
    v_add_u32 v240, v240, v2
    v_lshlrev_b32 v240, 4, v240
    s_lshl_b32 s57, s60, 9
    v_add_u32 v240, s57, v240
    s_lshl_b32 s57, s60, 3
    v_mov_b32 v241, s57
    v_lshlrev_b32 v118, 4, v3
    s_lshl_b32 s57, s60, 6
    v_add_u32 v116, s57, v118
    v_lshl_add_u32 v115, v18, 2, v116
    v_mov_b32 v112, v115
    v_add_u32 v113, 256, v115
    v_add_u32 v114, 512, v115
    s_barrier
    buffer_load_dwordx4 v[68:71], v15, s[36:39], s63 offen offset:0 nt
    buffer_load_dwordx4 v[72:75], v15, s[36:39], s63 offen offset:1024 nt
    buffer_load_dwordx4 v[76:79], v15, s[36:39], s63 offen offset:2048 nt
    buffer_load_dwordx4 v[80:83], v15, s[36:39], s63 offen offset:3072 nt
    s_add_u32 s63, s63, 0x10000
    s_mov_b32 s66, 0
    s_mov_b32 s87, 13
    v_mov_b32 v10, 0
L_lpro:
    ds_read_b32 v8, v10 offset:6464
    s_waitcnt lgkmcnt(0)
    v_cmp_ne_u32 vcc, 0, v8
    s_cbranch_vccnz L_qready
    s_cmp_lt_u32 s66, 4
    s_cbranch_scc1 L_lgo
    s_sleep 1
    s_branch L_lpro
L_lgo:
    s_mov_b32 m0, s61
    s_waitcnt vmcnt(4)
    buffer_load_dwordx4 v15, s[36:39], s63 offen offset:0 nt lds
    buffer_load_dwordx4 v15, s[36:39], s63 offen offset:1024 nt lds
    buffer_load_dwordx4 v15, s[36:39], s63 offen offset:2048 nt lds
    buffer_load_dwordx4 v15, s[36:39], s63 offen offset:3072 nt lds
    s_add_u32 s61, s61, 4096
    s_add_u32 s63, s63, 0x10000
    s_mov_b32 m0, s61
    s_waitcnt vmcnt(4)
    buffer_load_dwordx4 v15, s[36:39], s63 offen offset:0 nt lds
    buffer_load_dwordx4 v15, s[36:39], s63 offen offset:1024 nt lds
    buffer_load_dwordx4 v15, s[36:39], s63 offen offset:2048 nt lds
    buffer_load_dwordx4 v15, s[36:39], s63 offen offset:3072 nt lds
    s_add_u32 s61, s61, 4096
    s_add_u32 s63, s63, 0x10000
    s_add_u32 s66, s66, 2
    s_sub_u32 s87, s87, 1
    s_branch L_lpro
L_qready:
    ds_read_b128 v[20:23], v17 offset:4096
    s_waitcnt lgkmcnt(0)
    v_cmp_eq_u32 vcc, 0, v18
    s_nop 1
    v_cndmask_b32 v36, 0, v20, vcc
    v_cndmask_b32 v37, 0, v21, vcc
    v_cndmask_b32 v38, 0, v22, vcc
    v_cndmask_b32 v39, 0, v23, vcc
    v_cmp_eq_u32 vcc, 1, v18
    s_nop 1
    v_cndmask_b32 v40, 0, v20, vcc
    v_cndmask_b32 v41, 0, v21, vcc
    v_cndmask_b32 v42, 0, v22, vcc
    v_cndmask_b32 v43, 0, v23, vcc
    v_cmp_eq_u32 vcc, 2, v18
    s_nop 1
    v_cndmask_b32 v44, 0, v20, vcc
    v_cndmask_b32 v45, 0, v21, vcc
    v_cndmask_b32 v46, 0, v22, vcc
    v_cndmask_b32 v47, 0, v23, vcc
    v_cmp_eq_u32 vcc, 3, v18
    s_nop 1
    v_cndmask_b32 v48, 0, v20, vcc
    v_cndmask_b32 v49, 0, v21, vcc
    v_cndmask_b32 v50, 0, v22, vcc
    v_cndmask_b32 v51, 0, v23, vcc
    v_mov_b32 v17, 0
    v_mov_b32 v18, 1
L_kloop:
L_kfirst:
    s_sub_u32 s87, s87, 1
    s_cmp_lg_u32 s87, 0
    s_cbranch_scc1 L_kgo
    s_mov_b32 s44, s40
    s_mov_b32 s45, s41
    s_mov_b32 s63, s86
    v_mov_b32 v117, v16
L_kgo:
    s_waitcnt vmcnt(7)
    v_mfma_f32_16x16x32_bf16 v[20:23], v[52:55], v[36:39], 0
    buffer_load_dwordx4 v[52:55], v117, s[44:47], s63 offen offset:0 nt
    s_waitcnt vmcnt(7)
    v_mfma_f32_16x16x32_bf16 v[20:23], v[56:59], v[40:43], v[20:23]
    buffer_load_dwordx4 v[56:59], v117, s[44:47], s63 offen offset:1024 nt
    s_waitcnt vmcnt(7)
    v_mfma_f32_16x16x32_bf16 v[20:23], v[60:63], v[44:47], v[20:23]
    buffer_load_dwordx4 v[60:63], v117, s[44:47], s63 offen offset:2048 nt
    s_waitcnt vmcnt(7)
    v_mfma_f32_16x16x32_bf16 v[20:23], v[64:67], v[48:51], v[20:23]
    buffer_load_dwordx4 v[64:67], v117, s[44:47], s63 offen offset:3072 nt
    s_bfe_u32 s56, s63, 0x50010
    s_lshl_b32 s56, s56, 8
    s_add_u32 s63, s63, 0x10000
    s_nop 3
    v_mov_b32_dpp v8, v20 quad_perm:[0,0,0,0] row_mask:0xf bank_mask:0xf
    v_add_f32_dpp v8, v21, v8 quad_perm:[1,1,1,1] row_mask:0xf bank_mask:0xf
    v_add_f32_dpp v8, v22, v8 quad_perm:[2,2,2,2] row_mask:0xf bank_mask:0xf
    v_add_f32_dpp v8, v23, v8 quad_perm:[3,3,3,3] row_mask:0xf bank_mask:0xf
    v_cvt_pk_bf16_f32 v8, v8, v8
    v_and_b32 v8, 0xffff0000, v8
    v_mul_f32 v8, 0x3db504f3, v8
    v_cvt_pk_bf16_f32 v8, v8, v8
    v_and_b32 v8, 0xffff0000, v8
    v_max_f32 v12, v12, v8
    ds_write_b32 v112, v8 offset:8192
    v_add_u32 v112, s56, v115
    s_waitcnt vmcnt(7)
    v_mfma_f32_16x16x32_bf16 v[20:23], v[68:71], v[36:39], 0
    buffer_load_dwordx4 v[68:71], v117, s[44:47], s63 offen offset:0 nt
    s_waitcnt vmcnt(7)
    v_mfma_f32_16x16x32_bf16 v[20:23], v[72:75], v[40:43], v[20:23]
    buffer_load_dwordx4 v[72:75], v117, s[44:47], s63 offen offset:1024 nt
    s_waitcnt vmcnt(7)
    v_mfma_f32_16x16x32_bf16 v[20:23], v[76:79], v[44:47], v[20:23]
    buffer_load_dwordx4 v[76:79], v117, s[44:47], s63 offen offset:2048 nt
    s_waitcnt vmcnt(7)
    v_mfma_f32_16x16x32_bf16 v[20:23], v[80:83], v[48:51], v[20:23]
    buffer_load_dwordx4 v[80:83], v117, s[44:47], s63 offen offset:3072 nt
    s_bfe_u32 s56, s63, 0x50010
    s_lshl_b32 s56, s56, 8
    s_add_u32 s63, s63, 0x10000
    s_nop 3
    v_mov_b32_dpp v8, v20 quad_perm:[0,0,0,0] row_mask:0xf bank_mask:0xf
    v_add_f32_dpp v8, v21, v8 quad_perm:[1,1,1,1] row_mask:0xf bank_mask:0xf
    v_add_f32_dpp v8, v22, v8 quad_perm:[2,2,2,2] row_mask:0xf bank_mask:0xf
    v_add_f32_dpp v8, v23, v8 quad_perm:[3,3,3,3] row_mask:0xf bank_mask:0xf
    v_cvt_pk_bf16_f32 v8, v8, v8
    v_and_b32 v8, 0xffff0000, v8
    v_mul_f32 v8, 0x3db504f3, v8
    v_cvt_pk_bf16_f32 v8, v8, v8
    v_and_b32 v8, 0xffff0000, v8
    v_max_f32 v12, v12, v8
    ds_write_b32 v113, v8 offset:8192
    v_add_u32 v113, s56, v115
    s_cmp_eq_u32 s66, 0
    s_cbranch_scc1 L_knol
    s_waitcnt vmcnt(8)
L_kl:
    ds_read_b128 v[84:87], v19 offset:0
    ds_read_b128 v[88:91], v19 offset:1024
    ds_read_b128 v[92:95], v19 offset:2048
    ds_read_b128 v[96:99], v19 offset:3072
    v_add_u32 v19, 0x1000, v19
    s_waitcnt lgkmcnt(0)
    v_mfma_f32_16x16x32_bf16 v[20:23], v[84:87], v[36:39], 0
    v_mfma_f32_16x16x32_bf16 v[20:23], v[88:91], v[40:43], v[20:23]
    v_mfma_f32_16x16x32_bf16 v[20:23], v[92:95], v[44:47], v[20:23]
    v_mfma_f32_16x16x32_bf16 v[20:23], v[96:99], v[48:51], v[20:23]
    s_nop 7
    v_mov_b32_dpp v8, v20 quad_perm:[0,0,0,0] row_mask:0xf bank_mask:0xf
    v_add_f32_dpp v8, v21, v8 quad_perm:[1,1,1,1] row_mask:0xf bank_mask:0xf
    v_add_f32_dpp v8, v22, v8 quad_perm:[2,2,2,2] row_mask:0xf bank_mask:0xf
    v_add_f32_dpp v8, v23, v8 quad_perm:[3,3,3,3] row_mask:0xf bank_mask:0xf
    v_cvt_pk_bf16_f32 v8, v8, v8
    v_and_b32 v8, 0xffff0000, v8
    v_mul_f32 v8, 0x3db504f3, v8
    v_cvt_pk_bf16_f32 v8, v8, v8
    v_and_b32 v8, 0xffff0000, v8
    v_max_f32 v12, v12, v8
    ds_write_b32 v114, v8 offset:8192
    v_add_u32 v114, 256, v114
    s_sub_u32 s66, s66, 1
    s_bitcmp1_b32 s66, 0
    s_cbranch_scc1 L_kl
L_knol:
    s_cmp_lg_u32 s87, 0
    s_cbranch_scc1 L_kloop
    v_max_f32_dpp v12, v12, v12 row_ror:4 row_mask:0xf bank_mask:0xf
    s_nop 1
    v_max_f32_dpp v12, v12, v12 row_ror:8 row_mask:0xf bank_mask:0xf
    v_mov_b32 v10, v12
    s_nop 1
    v_permlane16_swap_b32 v12, v10
    v_max_f32 v12, v12, v10
    v_mov_b32 v10, v12
    s_nop 1
    v_permlane32_swap_b32 v12, v10
    v_max_f32 v12, v12, v10
    v_mul_f32 v13, 0xbfb8aa3b, v12
    s_mov_b32 s88, 13
L_vloop:
    ds_read_b128 v[100:103], v116 offset:8192
    ds_read_b128 v[104:107], v116 offset:8448
    v_add_u32 v116, 512, v116
    s_sub_u32 s88, s88, 1
    s_mov_b32 s94, s63
    s_add_u32 s95, s63, 0x10000
    s_add_u32 s63, s63, 0x20000
    s_waitcnt lgkmcnt(0)
    v_fma_f32 v100, v100, s33, v13
    v_fma_f32 v101, v101, s33, v13
    v_fma_f32 v102, v102, s33, v13
    v_fma_f32 v103, v103, s33, v13
    v_exp_f32 v100, v100
    v_exp_f32 v101, v101
    v_exp_f32 v102, v102
    v_exp_f32 v103, v103
    v_cvt_pk_bf16_f32 v108, v100, v100
    v_cvt_pk_bf16_f32 v109, v101, v101
    v_cvt_pk_bf16_f32 v110, v102, v102
    v_cvt_pk_bf16_f32 v111, v103, v103
    v_add_f32 v100, v100, v101
    v_add_f32 v102, v102, v103
    v_add_f32 v14, v14, v100
    v_add_f32 v14, v14, v102
    v_and_b32 v120, v108, v4
    v_and_b32 v121, v108, v5
    v_and_b32 v122, v108, v6
    v_and_b32 v123, v108, v7
    v_and_b32 v124, v109, v4
    v_and_b32 v125, v109, v5
    v_and_b32 v126, v109, v6
    v_and_b32 v127, v109, v7
    v_and_b32 v128, v110, v4
    v_and_b32 v129, v110, v5
    v_and_b32 v130, v110, v6
    v_and_b32 v131, v110, v7
    v_and_b32 v132, v111, v4
    v_and_b32 v133, v111, v5
    v_and_b32 v134, v111, v6
    v_and_b32 v135, v111, v7
    v_fma_f32 v104, v104, s33, v13
    v_fma_f32 v105, v105, s33, v13
    v_fma_f32 v106, v106, s33, v13
    v_fma_f32 v107, v107, s33, v13
    v_exp_f32 v104, v104
    v_exp_f32 v105, v105
    v_exp_f32 v106, v106
    v_exp_f32 v107, v107
    v_cvt_pk_bf16_f32 v108, v104, v104
    v_cvt_pk_bf16_f32 v109, v105, v105
    v_cvt_pk_bf16_f32 v110, v106, v106
    v_cvt_pk_bf16_f32 v111, v107, v107
    v_add_f32 v104, v104, v105
    v_add_f32 v106, v106, v107
    v_add_f32 v14, v14, v104
    v_add_f32 v14, v14, v106
    v_and_b32 v84, v108, v4
    v_and_b32 v85, v108, v5
    v_and_b32 v86, v108, v6
    v_and_b32 v87, v108, v7
    v_and_b32 v88, v109, v4
    v_and_b32 v89, v109, v5
    v_and_b32 v90, v109, v6
    v_and_b32 v91, v109, v7
    v_and_b32 v92, v110, v4
    v_and_b32 v93, v110, v5
    v_and_b32 v94, v110, v6
    v_and_b32 v95, v110, v7
    v_and_b32 v96, v111, v4
    v_and_b32 v97, v111, v5
    v_and_b32 v98, v111, v6
    v_and_b32 v99, v111, v7
    s_cmp_lg_u32 s88, 0
    s_cbranch_scc1 L_vnd
    s_waitcnt lgkmcnt(0)
    s_add_u32 s68, s69, 1
    s_lshl_b32 s57, s68, 12
    s_add_u32 s57, s57, s90
    s_cmp_lt_u32 s68, 96
    s_cselect_b32 s94, s57, 0x40000000
    s_mov_b32 s95, s94
    s_mov_b32 s44, s36
    s_mov_b32 s45, s37
    v_mov_b32 v117, v15
L_vnd:
    s_waitcnt vmcnt(7)
    v_mfma_f32_16x16x32_bf16 v[24:27], v[52:55], v[120:123], v[24:27]
    buffer_load_dwordx4 v[52:55], v117, s[44:47], s94 offen offset:0 nt
    s_waitcnt vmcnt(7)
    v_mfma_f32_16x16x32_bf16 v[24:27], v[56:59], v[124:127], v[24:27]
    buffer_load_dwordx4 v[56:59], v117, s[44:47], s94 offen offset:1024 nt
    s_waitcnt vmcnt(7)
    v_mfma_f32_16x16x32_bf16 v[24:27], v[60:63], v[128:131], v[24:27]
    buffer_load_dwordx4 v[60:63], v117, s[44:47], s94 offen offset:2048 nt
    s_waitcnt vmcnt(7)
    v_mfma_f32_16x16x32_bf16 v[24:27], v[64:67], v[132:135], v[24:27]
    buffer_load_dwordx4 v[64:67], v117, s[44:47], s94 offen offset:3072 nt
    s_waitcnt vmcnt(7)
    v_mfma_f32_16x16x32_bf16 v[24:27], v[68:71], v[84:87], v[24:27]
    buffer_load_dwordx4 v[68:71], v16, s[40:43], s95 offen offset:0 nt
    s_waitcnt vmcnt(7)
    v_mfma_f32_16x16x32_bf16 v[24:27], v[72:75], v[88:91], v[24:27]
    buffer_load_dwordx4 v[72:75], v16, s[40:43], s95 offen offset:1024 nt
    s_waitcnt vmcnt(7)
    v_mfma_f32_16x16x32_bf16 v[24:27], v[76:79], v[92:95], v[24:27]
    buffer_load_dwordx4 v[76:79], v16, s[40:43], s95 offen offset:2048 nt
    s_waitcnt vmcnt(7)
    v_mfma_f32_16x16x32_bf16 v[24:27], v[80:83], v[96:99], v[24:27]
    buffer_load_dwordx4 v[80:83], v16, s[40:43], s95 offen offset:3072 nt
    s_cmp_gt_u32 s88, 1
    s_cbranch_scc1 L_vnc
    s_cmp_ge_i32 s68, 96
    s_cbranch_scc1 L_cl_1
    s_mov_b32 s69, 1
    s_atomic_add s69, s[26:27], s67 glc
L_cl_1:
L_vnc:
    s_cmp_lg_u32 s88, 0
    s_cbranch_scc1 L_vloop
    v_mul_f32 v14, 0x3e800000, v14
L_dloop:
    s_cmp_ge_u32 s94, 0x40000000
    s_cbranch_scc1 L_sdone
    s_waitcnt vmcnt(4)
    v_mfma_f32_16x16x32_bf16 v[20:23], v[52:55], v[36:39], 0
    v_mfma_f32_16x16x32_bf16 v[20:23], v[56:59], v[40:43], v[20:23]
    v_mfma_f32_16x16x32_bf16 v[20:23], v[60:63], v[44:47], v[20:23]
    v_mfma_f32_16x16x32_bf16 v[20:23], v[64:67], v[48:51], v[20:23]
    s_waitcnt lgkmcnt(0)
    s_add_u32 s68, s69, 1
    s_lshl_b32 s57, s68, 12
    s_add_u32 s57, s57, s90
    s_cmp_lt_u32 s68, 96
    s_cselect_b32 s94, s57, 0x40000000
    buffer_load_dwordx4 v[52:55], v15, s[36:39], s94 offen offset:0 nt
    buffer_load_dwordx4 v[56:59], v15, s[36:39], s94 offen offset:1024 nt
    buffer_load_dwordx4 v[60:63], v15, s[36:39], s94 offen offset:2048 nt
    buffer_load_dwordx4 v[64:67], v15, s[36:39], s94 offen offset:3072 nt
    s_cmp_ge_i32 s68, 96
    s_cbranch_scc1 L_cl_2
    s_mov_b32 s69, 1
    s_atomic_add s69, s[26:27], s67 glc
L_cl_2:
    v_mov_b32_dpp v8, v20 quad_perm:[0,0,0,0] row_mask:0xf bank_mask:0xf
    v_add_f32_dpp v8, v21, v8 quad_perm:[1,1,1,1] row_mask:0xf bank_mask:0xf
    v_add_f32_dpp v8, v22, v8 quad_perm:[2,2,2,2] row_mask:0xf bank_mask:0xf
    v_add_f32_dpp v8, v23, v8 quad_perm:[3,3,3,3] row_mask:0xf bank_mask:0xf
    v_cvt_pk_bf16_f32 v8, v8, v8
    v_and_b32 v8, 0xffff0000, v8
    v_mul_f32 v8, 0x3db504f3, v8
    v_cvt_pk_bf16_f32 v8, v8, v8
    v_and_b32 v8, 0xffff0000, v8
    v_cmp_gt_f32 vcc, v8, v12
    s_cbranch_vccnz L_slow
L_back:
    v_fma_f32 v8, v8, s33, v13
    v_exp_f32 v8, v8
    s_nop 0
    v_add_f32 v14, v14, v8
    v_cvt_pk_bf16_f32 v11, v8, v8
    s_nop 1
    v_and_b32_dpp v120, v11, v4 row_newbcast:0 row_mask:0xf bank_mask:0xf
    v_and_b32_dpp v121, v11, v5 row_newbcast:0 row_mask:0xf bank_mask:0xf
    v_and_b32_dpp v122, v11, v6 row_newbcast:0 row_mask:0xf bank_mask:0xf
    v_and_b32_dpp v123, v11, v7 row_newbcast:0 row_mask:0xf bank_mask:0xf
    v_and_b32_dpp v124, v11, v4 row_newbcast:4 row_mask:0xf bank_mask:0xf
    v_and_b32_dpp v125, v11, v5 row_newbcast:4 row_mask:0xf bank_mask:0xf
    v_and_b32_dpp v126, v11, v6 row_newbcast:4 row_mask:0xf bank_mask:0xf
    v_and_b32_dpp v127, v11, v7 row_newbcast:4 row_mask:0xf bank_mask:0xf
    v_and_b32_dpp v128, v11, v4 row_newbcast:8 row_mask:0xf bank_mask:0xf
    v_and_b32_dpp v129, v11, v5 row_newbcast:8 row_mask:0xf bank_mask:0xf
    v_and_b32_dpp v130, v11, v6 row_newbcast:8 row_mask:0xf bank_mask:0xf
    v_and_b32_dpp v131, v11, v7 row_newbcast:8 row_mask:0xf bank_mask:0xf
    v_and_b32_dpp v132, v11, v4 row_newbcast:12 row_mask:0xf bank_mask:0xf
    v_and_b32_dpp v133, v11, v5 row_newbcast:12 row_mask:0xf bank_mask:0xf
    v_and_b32_dpp v134, v11, v6 row_newbcast:12 row_mask:0xf bank_mask:0xf
    v_and_b32_dpp v135, v11, v7 row_newbcast:12 row_mask:0xf bank_mask:0xf
    s_waitcnt vmcnt(4)
    v_mfma_f32_16x16x32_bf16 v[24:27], v[68:71], v[120:123], v[24:27]
    v_mfma_f32_16x16x32_bf16 v[24:27], v[72:75], v[124:127], v[24:27]
    v_mfma_f32_16x16x32_bf16 v[24:27], v[76:79], v[128:131], v[24:27]
    v_mfma_f32_16x16x32_bf16 v[24:27], v[80:83], v[132:135], v[24:27]
    buffer_load_dwordx4 v[68:71], v16, s[40:43], s94 offen offset:0 nt
    buffer_load_dwordx4 v[72:75], v16, s[40:43], s94 offen offset:1024 nt
    buffer_load_dwordx4 v[76:79], v16, s[40:43], s94 offen offset:2048 nt
    buffer_load_dwordx4 v[80:83], v16, s[40:43], s94 offen offset:3072 nt
    s_branch L_dloop
L_slow:
    s_nop 0
    v_max_f32_dpp v9, v8, v8 row_ror:4 row_mask:0xf bank_mask:0xf
    s_nop 1
    v_max_f32_dpp v9, v9, v9 row_ror:8 row_mask:0xf bank_mask:0xf
    v_mov_b32 v10, v9
    s_nop 1
    v_permlane16_swap_b32 v9, v10
    v_max_f32 v9, v9, v10
    v_mov_b32 v10, v9
    s_nop 1
    v_permlane32_swap_b32 v9, v10
    v_max3_f32 v9, v9, v10, v12
    v_sub_f32 v10, v12, v9
    v_mul_f32 v10, s33, v10
    v_exp_f32 v10, v10
    v_mov_b32 v12, v9
    v_mul_f32 v13, 0xbfb8aa3b, v9
    v_mul_f32 v24, v24, v10
    v_mul_f32 v25, v25, v10
    v_mul_f32 v26, v26, v10
    v_mul_f32 v27, v27, v10
    v_mul_f32 v14, v14, v10
    s_branch L_back
L_sdone:
    ds_write_b32 v17, v18 offset:6468
    s_mov_b32 exec_lo, 0x00ff00ff
    s_mov_b32 exec_hi, 0x00ff00ff
    s_nop 3
    ds_write_b128 v240, v[24:27] offset:4352
    s_mov_b64 exec, -1
    v_add_f32_dpp v14, v14, v14 row_ror:4 row_mask:0xf bank_mask:0xf
    s_nop 1
    v_add_f32_dpp v14, v14, v14 row_ror:8 row_mask:0xf bank_mask:0xf
    v_mov_b32 v10, v14
    s_nop 1
    v_permlane16_swap_b32 v14, v10
    v_add_f32 v14, v14, v10
    v_mov_b32 v10, v14
    s_nop 1
    v_permlane32_swap_b32 v14, v10
    v_add_f32 v14, v14, v10
    v_mov_b32 v13, v14
    ds_write_b64 v241, v[12:13] offset:6400
    s_waitcnt lgkmcnt(0)
    s_barrier
    s_endpgm
L_A0:
    s_setprio 3
    v_mov_b32 v245, 7
    v_lshlrev_b32 v16, 4, v1
    v_mov_b32 v20, -1
    v_mov_b32 v21, -1
    v_mov_b32 v22, -1
    v_mov_b32 v23, -1
    s_lshl_b32 s63, s31, 10
    v_lshlrev_b32 v17, 17, v3
    v_lshl_add_u32 v17, v2, 4, v17
    s_lshl_b32 s56, s32, 19
    s_lshl_b32 s57, s28, 8
    s_add_u32 s56, s56, s57
    s_waitcnt lgkmcnt(0)
    s_mov_b32 s36, s4
    s_and_b32 s37, s5, 0xffff
    s_mov_b32 s38, 0x800
    s_mov_b32 s39, 0x20000
    buffer_load_dwordx4 v[28:31], v16, s[36:39], 0 offen
    buffer_load_dwordx4 v[32:35], v16, s[36:39], 0 offen offset:1024
    s_mov_b32 s48, s26
    s_and_b32 s49, s27, 0xffff
    s_mov_b32 s50, 0x200000
    s_mov_b32 s51, 0x20000
    s_mov_b32 s58, 0x140000
    s_load_dword s34, s[26:27], s58
    s_lshr_b32 s59, s31, 2
    s_mul_i32 s59, s59, 512
    s_add_u32 s59, s59, 0x150000
    s_mov_b64 exec, 0xff
    buffer_store_dwordx4 v[20:23], v16, s[48:51], s59 offen sc1
    s_mov_b64 exec, -1
    s_mov_b32 s40, s10
    s_and_b32 s41, s11, 0xffff
    s_mov_b32 s42, 0x400000
    s_mov_b32 s43, 0x20000
    buffer_load_dwordx4 v[52:55], v17, s[40:43], s56 offen nt
    s_add_u32 s56, s56, 8192
    buffer_load_dwordx4 v[56:59], v17, s[40:43], s56 offen nt
    s_add_u32 s56, s56, 8192
    buffer_load_dwordx4 v[60:63], v17, s[40:43], s56 offen nt
    s_add_u32 s56, s56, 8192
    buffer_load_dwordx4 v[64:67], v17, s[40:43], s56 offen nt
    s_add_u32 s56, s56, 8192
    buffer_load_dwordx4 v[68:71], v17, s[40:43], s56 offen nt
    s_add_u32 s56, s56, 8192
    buffer_load_dwordx4 v[72:75], v17, s[40:43], s56 offen nt
    s_add_u32 s56, s56, 8192
    buffer_load_dwordx4 v[76:79], v17, s[40:43], s56 offen nt
    s_add_u32 s56, s56, 8192
    buffer_load_dwordx4 v[80:83], v17, s[40:43], s56 offen nt
    s_add_u32 s56, s56, 8192
    buffer_load_dwordx4 v[84:87], v17, s[40:43], s56 offen nt
    s_add_u32 s56, s56, 8192
    buffer_load_dwordx4 v[88:91], v17, s[40:43], s56 offen nt
    s_add_u32 s56, s56, 8192
    buffer_load_dwordx4 v[92:95], v17, s[40:43], s56 offen nt
    s_add_u32 s56, s56, 8192
    buffer_load_dwordx4 v[96:99], v17, s[40:43], s56 offen nt
    s_add_u32 s56, s56, 8192
    buffer_load_dwordx4 v[100:103], v17, s[40:43], s56 offen nt
    s_add_u32 s56, s56, 8192
    buffer_load_dwordx4 v[104:107], v17, s[40:43], s56 offen nt
    s_add_u32 s56, s56, 8192
    buffer_load_dwordx4 v[108:111], v17, s[40:43], s56 offen nt
    s_add_u32 s56, s56, 8192
    buffer_load_dwordx4 v[112:115], v17, s[40:43], s56 offen nt
    s_barrier
    v_and_b32 v8, 1, v1
    v_lshlrev_b32 v8, 4, v8
    v_mov_b32 v9, 0xffff
    v_lshlrev_b32 v9, v8, v9
    v_bfe_u32 v8, v1, 1, 2
    v_cmp_eq_u32 vcc, 0, v8
    s_nop 1
    v_cndmask_b32 v4, 0, v9, vcc
    v_cmp_eq_u32 vcc, 1, v8
    s_nop 1
    v_cndmask_b32 v5, 0, v9, vcc
    v_cmp_eq_u32 vcc, 2, v8
    s_nop 1
    v_cndmask_b32 v6, 0, v9, vcc
    v_cmp_eq_u32 vcc, 3, v8
    s_nop 1
    v_cndmask_b32 v7, 0, v9, vcc
    s_waitcnt vmcnt(17)
    v_lshlrev_b32 v180, 16, v28
    v_and_b32 v181, 0xffff0000, v28
    v_lshlrev_b32 v182, 16, v29
    v_and_b32 v183, 0xffff0000, v29
    v_lshlrev_b32 v184, 16, v30
    v_and_b32 v185, 0xffff0000, v30
    v_lshlrev_b32 v186, 16, v31
    v_and_b32 v187, 0xffff0000, v31
    v_lshlrev_b32 v188, 16, v32
    v_and_b32 v189, 0xffff0000, v32
    v_lshlrev_b32 v190, 16, v33
    v_and_b32 v191, 0xffff0000, v33
    v_lshlrev_b32 v192, 16, v34
    v_and_b32 v193, 0xffff0000, v34
    v_lshlrev_b32 v194, 16, v35
    v_and_b32 v195, 0xffff0000, v35
    v_add_f32 v196, v180, v181
    v_add_f32 v197, v188, v189
    v_add_f32 v196, v196, v182
    v_add_f32 v197, v197, v190
    v_add_f32 v196, v196, v183
    v_add_f32 v197, v197, v191
    v_add_f32 v196, v196, v184
    v_add_f32 v197, v197, v192
    v_add_f32 v196, v196, v185
    v_add_f32 v197, v197, v193
    v_add_f32 v196, v196, v186
    v_add_f32 v197, v197, v194
    v_add_f32 v196, v196, v187
    v_add_f32 v197, v197, v195
    s_nop 0
    v_add_f32_dpp v196, v196, v196 quad_perm:[1,0,3,2] row_mask:0xf bank_mask:0xf
    v_add_f32_dpp v197, v197, v197 quad_perm:[1,0,3,2] row_mask:0xf bank_mask:0xf
    s_nop 0
    v_add_f32_dpp v196, v196, v196 quad_perm:[2,3,0,1] row_mask:0xf bank_mask:0xf
    v_add_f32_dpp v197, v197, v197 quad_perm:[2,3,0,1] row_mask:0xf bank_mask:0xf
    s_nop 0
    v_add_f32_dpp v196, v196, v196 row_ror:4 row_mask:0xf bank_mask:0xf
    v_add_f32_dpp v197, v197, v197 row_ror:4 row_mask:0xf bank_mask:0xf
    s_nop 0
    v_add_f32_dpp v196, v196, v196 row_ror:8 row_mask:0xf bank_mask:0xf
    v_add_f32_dpp v197, v197, v197 row_ror:8 row_mask:0xf bank_mask:0xf
    v_mov_b32 v198, v196
    v_mov_b32 v199, v197
    s_nop 0
    v_permlane16_swap_b32 v196, v198
    v_permlane16_swap_b32 v197, v199
    v_add_f32 v196, v196, v198
    v_add_f32 v197, v197, v199
    v_mov_b32 v198, v196
    v_mov_b32 v199, v197
    s_nop 0
    v_permlane32_swap_b32 v196, v198
    v_permlane32_swap_b32 v197, v199
    v_add_f32 v196, v196, v198
    v_add_f32 v197, v197, v199
    v_mul_f32 v196, 0x3b000000, v196
    v_mul_f32 v197, 0x3b000000, v197
    v_sub_f32 v200, v180, v196
    v_sub_f32 v201, v181, v196
    v_sub_f32 v202, v182, v196
    v_sub_f32 v203, v183, v196
    v_sub_f32 v204, v184, v196
    v_sub_f32 v205, v185, v196
    v_sub_f32 v206, v186, v196
    v_sub_f32 v207, v187, v196
    v_sub_f32 v208, v188, v197
    v_sub_f32 v209, v189, v197
    v_sub_f32 v210, v190, v197
    v_sub_f32 v211, v191, v197
    v_sub_f32 v212, v192, v197
    v_sub_f32 v213, v193, v197
    v_sub_f32 v214, v194, v197
    v_sub_f32 v215, v195, v197
    v_mul_f32 v216, v200, v200
    v_mul_f32 v217, v208, v208
    v_fmac_f32 v216, v201, v201
    v_fmac_f32 v217, v209, v209
    v_fmac_f32 v216, v202, v202
    v_fmac_f32 v217, v210, v210
    v_fmac_f32 v216, v203, v203
    v_fmac_f32 v217, v211, v211
    v_fmac_f32 v216, v204, v204
    v_fmac_f32 v217, v212, v212
    v_fmac_f32 v216, v205, v205
    v_fmac_f32 v217, v213, v213
    v_fmac_f32 v216, v206, v206
    v_fmac_f32 v217, v214, v214
    v_fmac_f32 v216, v207, v207
    v_fmac_f32 v217, v215, v215
    s_nop 0
    v_add_f32_dpp v216, v216, v216 quad_perm:[1,0,3,2] row_mask:0xf bank_mask:0xf
    v_add_f32_dpp v217, v217, v217 quad_perm:[1,0,3,2] row_mask:0xf bank_mask:0xf
    s_nop 0
    v_add_f32_dpp v216, v216, v216 quad_perm:[2,3,0,1] row_mask:0xf bank_mask:0xf
    v_add_f32_dpp v217, v217, v217 quad_perm:[2,3,0,1] row_mask:0xf bank_mask:0xf
    s_nop 0
    v_add_f32_dpp v216, v216, v216 row_ror:4 row_mask:0xf bank_mask:0xf
    v_add_f32_dpp v217, v217, v217 row_ror:4 row_mask:0xf bank_mask:0xf
    s_nop 0
    v_add_f32_dpp v216, v216, v216 row_ror:8 row_mask:0xf bank_mask:0xf
    v_add_f32_dpp v217, v217, v217 row_ror:8 row_mask:0xf bank_mask:0xf
    v_mov_b32 v198, v216
    v_mov_b32 v199, v217
    s_nop 0
    v_permlane16_swap_b32 v216, v198
    v_permlane16_swap_b32 v217, v199
    v_add_f32 v216, v216, v198
    v_add_f32 v217, v217, v199
    v_mov_b32 v198, v216
    v_mov_b32 v199, v217
    s_nop 0
    v_permlane32_swap_b32 v216, v198
    v_permlane32_swap_b32 v217, v199
    v_add_f32 v216, v216, v198
    v_add_f32 v217, v217, v199
    v_mul_f32 v216, 0x3b000000, v216
    v_mul_f32 v217, 0x3b000000, v217
    v_cvt_pk_bf16_f32 v196, v196, v196
    v_cvt_pk_bf16_f32 v197, v197, v197
    v_cvt_pk_bf16_f32 v216, v216, v216
    v_cvt_pk_bf16_f32 v217, v217, v217
    v_and_b32 v196, 0xffff0000, v196
    v_and_b32 v197, 0xffff0000, v197
    v_and_b32 v216, 0xffff0000, v216
    v_and_b32 v217, 0xffff0000, v217
    v_add_f32 v216, 0x3727c5ac, v216
    v_add_f32 v217, 0x3727c5ac, v217
    v_cvt_pk_bf16_f32 v216, v216, v216
    v_cvt_pk_bf16_f32 v217, v217, v217
    v_and_b32 v216, 0xffff0000, v216
    v_and_b32 v217, 0xffff0000, v217
    v_sqrt_f32 v216, v216
    v_sqrt_f32 v217, v217
    v_cvt_pk_bf16_f32 v216, v216, v216
    v_cvt_pk_bf16_f32 v217, v217, v217
    v_and_b32 v216, 0xffff0000, v216
    v_and_b32 v217, 0xffff0000, v217
    v_rcp_f32 v216, v216
    v_rcp_f32 v217, v217
    v_sub_f32 v200, v180, v196
    v_sub_f32 v201, v181, v196
    v_sub_f32 v202, v182, v196
    v_sub_f32 v203, v183, v196
    v_sub_f32 v204, v184, v196
    v_sub_f32 v205, v185, v196
    v_sub_f32 v206, v186, v196
    v_sub_f32 v207, v187, v196
    v_sub_f32 v208, v188, v197
    v_sub_f32 v209, v189, v197
    v_sub_f32 v210, v190, v197
    v_sub_f32 v211, v191, v197
    v_sub_f32 v212, v192, v197
    v_sub_f32 v213, v193, v197
    v_sub_f32 v214, v194, v197
    v_sub_f32 v215, v195, v197
    v_cvt_pk_bf16_f32 v200, v200, v200
    v_cvt_pk_bf16_f32 v201, v201, v201
    v_cvt_pk_bf16_f32 v202, v202, v202
    v_cvt_pk_bf16_f32 v203, v203, v203
    v_cvt_pk_bf16_f32 v204, v204, v204
    v_cvt_pk_bf16_f32 v205, v205, v205
    v_cvt_pk_bf16_f32 v206, v206, v206
    v_cvt_pk_bf16_f32 v207, v207, v207
    v_cvt_pk_bf16_f32 v208, v208, v208
    v_cvt_pk_bf16_f32 v209, v209, v209
    v_cvt_pk_bf16_f32 v210, v210, v210
    v_cvt_pk_bf16_f32 v211, v211, v211
    v_cvt_pk_bf16_f32 v212, v212, v212
    v_cvt_pk_bf16_f32 v213, v213, v213
    v_cvt_pk_bf16_f32 v214, v214, v214
    v_cvt_pk_bf16_f32 v215, v215, v215
    v_and_b32 v200, 0xffff0000, v200
    v_and_b32 v201, 0xffff0000, v201
    v_and_b32 v202, 0xffff0000, v202
    v_and_b32 v203, 0xffff0000, v203
    v_and_b32 v204, 0xffff0000, v204
    v_and_b32 v205, 0xffff0000, v205
    v_and_b32 v206, 0xffff0000, v206
    v_and_b32 v207, 0xffff0000, v207
    v_and_b32 v208, 0xffff0000, v208
    v_and_b32 v209, 0xffff0000, v209
    v_and_b32 v210, 0xffff0000, v210
    v_and_b32 v211, 0xffff0000, v211
    v_and_b32 v212, 0xffff0000, v212
    v_and_b32 v213, 0xffff0000, v213
    v_and_b32 v214, 0xffff0000, v214
    v_and_b32 v215, 0xffff0000, v215
    v_mul_f32 v200, v200, v216
    v_mul_f32 v201, v201, v216
    v_mul_f32 v202, v202, v216
    v_mul_f32 v203, v203, v216
    v_mul_f32 v204, v204, v216
    v_mul_f32 v205, v205, v216
    v_mul_f32 v206, v206, v216
    v_mul_f32 v207, v207, v216
    v_mul_f32 v208, v208, v217
    v_mul_f32 v209, v209, v217
    v_mul_f32 v210, v210, v217
    v_mul_f32 v211, v211, v217
    v_mul_f32 v212, v212, v217
    v_mul_f32 v213, v213, v217
    v_mul_f32 v214, v214, v217
    v_mul_f32 v215, v215, v217
    v_cvt_pk_bf16_f32 v200, v200, v200
    v_cvt_pk_bf16_f32 v201, v201, v201
    v_cvt_pk_bf16_f32 v202, v202, v202
    v_cvt_pk_bf16_f32 v203, v203, v203
    v_cvt_pk_bf16_f32 v204, v204, v204
    v_cvt_pk_bf16_f32 v205, v205, v205
    v_cvt_pk_bf16_f32 v206, v206, v206
    v_cvt_pk_bf16_f32 v207, v207, v207
    v_cvt_pk_bf16_f32 v208, v208, v208
    v_cvt_pk_bf16_f32 v209, v209, v209
    v_cvt_pk_bf16_f32 v210, v210, v210
    v_cvt_pk_bf16_f32 v211, v211, v211
    v_cvt_pk_bf16_f32 v212, v212, v212
    v_cvt_pk_bf16_f32 v213, v213, v213
    v_cvt_pk_bf16_f32 v214, v214, v214
    v_cvt_pk_bf16_f32 v215, v215, v215
    v_lshlrev_b32 v18, 5, v1
    ds_write_b128 v18, v[200:203] offset:0
    ds_write_b128 v18, v[204:207] offset:16
    ds_write_b128 v18, v[208:211] offset:2048
    ds_write_b128 v18, v[212:215] offset:2064
    v_lshrrev_b32 v8, 3, v2
    v_lshlrev_b32 v15, 11, v8
    v_lshl_add_u32 v15, v3, 6, v15
    s_lshl_b32 s56, s32, 8
    v_add_u32 v18, s56, v15
    s_waitcnt lgkmcnt(0)
    s_add_u32 s35, s34, 1
    v_and_b32 v245, s35, v245
    ds_read_b128 v[36:39], v18 offset:0
    ds_read_b128 v[40:43], v18 offset:16
    ds_read_b128 v[44:47], v18 offset:32
    ds_read_b128 v[48:51], v18 offset:48
    s_waitcnt lgkmcnt(0)
    v_and_b32 v28, v36, v4
    v_and_b32 v29, v36, v5
    v_and_b32 v30, v36, v6
    v_and_b32 v31, v36, v7
    v_and_b32 v32, v37, v4
    v_and_b32 v33, v37, v5
    v_and_b32 v34, v37, v6
    v_and_b32 v35, v37, v7
    s_waitcnt vmcnt(12)
    v_mfma_f32_16x16x32_bf16 v[24:27], v[52:55], v[28:31], 0
    v_and_b32 v28, v38, v4
    v_and_b32 v29, v38, v5
    v_and_b32 v30, v38, v6
    v_and_b32 v31, v38, v7
    v_mfma_f32_16x16x32_bf16 v[24:27], v[56:59], v[32:35], v[24:27]
    v_and_b32 v32, v39, v4
    v_and_b32 v33, v39, v5
    v_and_b32 v34, v39, v6
    v_and_b32 v35, v39, v7
    v_mfma_f32_16x16x32_bf16 v[24:27], v[60:63], v[28:31], v[24:27]
    v_and_b32 v28, v40, v4
    v_and_b32 v29, v40, v5
    v_and_b32 v30, v40, v6
    v_and_b32 v31, v40, v7
    v_mfma_f32_16x16x32_bf16 v[24:27], v[64:67], v[32:35], v[24:27]
    v_and_b32 v32, v41, v4
    v_and_b32 v33, v41, v5
    v_and_b32 v34, v41, v6
    v_and_b32 v35, v41, v7
    s_waitcnt vmcnt(8)
    v_mfma_f32_16x16x32_bf16 v[24:27], v[68:71], v[28:31], v[24:27]
    v_and_b32 v28, v42, v4
    v_and_b32 v29, v42, v5
    v_and_b32 v30, v42, v6
    v_and_b32 v31, v42, v7
    v_mfma_f32_16x16x32_bf16 v[24:27], v[72:75], v[32:35], v[24:27]
    v_and_b32 v32, v43, v4
    v_and_b32 v33, v43, v5
    v_and_b32 v34, v43, v6
    v_and_b32 v35, v43, v7
    v_mfma_f32_16x16x32_bf16 v[24:27], v[76:79], v[28:31], v[24:27]
    v_and_b32 v28, v44, v4
    v_and_b32 v29, v44, v5
    v_and_b32 v30, v44, v6
    v_and_b32 v31, v44, v7
    v_mfma_f32_16x16x32_bf16 v[24:27], v[80:83], v[32:35], v[24:27]
    v_and_b32 v32, v45, v4
    v_and_b32 v33, v45, v5
    v_and_b32 v34, v45, v6
    v_and_b32 v35, v45, v7
    s_waitcnt vmcnt(4)
    v_mfma_f32_16x16x32_bf16 v[24:27], v[84:87], v[28:31], v[24:27]
    v_and_b32 v28, v46, v4
    v_and_b32 v29, v46, v5
    v_and_b32 v30, v46, v6
    v_and_b32 v31, v46, v7
    v_mfma_f32_16x16x32_bf16 v[24:27], v[88:91], v[32:35], v[24:27]
    v_and_b32 v32, v47, v4
    v_and_b32 v33, v47, v5
    v_and_b32 v34, v47, v6
    v_and_b32 v35, v47, v7
    v_mfma_f32_16x16x32_bf16 v[24:27], v[92:95], v[28:31], v[24:27]
    v_and_b32 v28, v48, v4
    v_and_b32 v29, v48, v5
    v_and_b32 v30, v48, v6
    v_and_b32 v31, v48, v7
    v_mfma_f32_16x16x32_bf16 v[24:27], v[96:99], v[32:35], v[24:27]
    v_and_b32 v32, v49, v4
    v_and_b32 v33, v49, v5
    v_and_b32 v34, v49, v6
    v_and_b32 v35, v49, v7
    s_waitcnt vmcnt(0)
    v_mfma_f32_16x16x32_bf16 v[24:27], v[100:103], v[28:31], v[24:27]
    v_and_b32 v28, v50, v4
    v_and_b32 v29, v50, v5
    v_and_b32 v30, v50, v6
    v_and_b32 v31, v50, v7
    v_mfma_f32_16x16x32_bf16 v[24:27], v[104:107], v[32:35], v[24:27]
    v_and_b32 v32, v51, v4
    v_and_b32 v33, v51, v5
    v_and_b32 v34, v51, v6
    v_and_b32 v35, v51, v7
    v_mfma_f32_16x16x32_bf16 v[24:27], v[108:111], v[28:31], v[24:27]
    s_nop 0
    v_mfma_f32_16x16x32_bf16 v[24:27], v[112:115], v[32:35], v[24:27]
    s_nop 7
    v_bfi_b32 v24, 7, v245, v24
    v_bfi_b32 v25, 7, v245, v25
    v_bfi_b32 v26, 7, v245, v26
    v_bfi_b32 v27, 7, v245, v27
    buffer_store_dwordx4 v[24:27], v16, s[48:51], s63 offen offset:0 sc1
    s_barrier
    s_cmp_ge_u32 s31, 88
    s_cselect_b32 s56, 88, 0
    s_cselect_b32 s44, s18, s16
    s_cselect_b32 s45, s19, s17
    s_and_b32 s45, s45, 0xffff
    s_sub_u32 s56, s31, s56
    s_cmp_lt_u32 s31, 176
    s_cselect_b32 s46, 1409024, 0
    s_mov_b32 s47, 0x20000
    s_lshr_b32 s57, s56, 3
    s_and_b32 s61, s56, 7
    s_mul_i32 s59, s61, 176128
    s_lshl_b32 s60, s57, 8
    s_add_u32 s59, s59, s60
    v_mul_u32_u24 v17, 44032, v3
    v_lshl_add_u32 v17, v2, 4, v17
    s_lshl_b32 s60, s57, 4
    v_add_u32 v8, s60, v2
    v_cmp_gt_u32 vcc, 172, v8
    v_mov_b32 v9, 0x40000000
    s_nop 0
    v_cndmask_b32 v17, v9, v17, vcc
    buffer_load_dwordx4 v[116:119], v17, s[44:47], s59 offen nt
    s_add_u32 s59, s59, 2752
    buffer_load_dwordx4 v[120:123], v17, s[44:47], s59 offen nt
    s_add_u32 s59, s59, 2752
    buffer_load_dwordx4 v[124:127], v17, s[44:47], s59 offen nt
    s_add_u32 s59, s59, 2752
    buffer_load_dwordx4 v[128:131], v17, s[44:47], s59 offen nt
    s_add_u32 s59, s59, 2752
    buffer_load_dwordx4 v[132:135], v17, s[44:47], s59 offen nt
    s_add_u32 s59, s59, 2752
    buffer_load_dwordx4 v[136:139], v17, s[44:47], s59 offen nt
    s_add_u32 s59, s59, 2752
    buffer_load_dwordx4 v[140:143], v17, s[44:47], s59 offen nt
    s_add_u32 s59, s59, 2752
    buffer_load_dwordx4 v[144:147], v17, s[44:47], s59 offen nt
    s_add_u32 s59, s59, 2752
    buffer_load_dwordx4 v[148:151], v17, s[44:47], s59 offen nt
    s_add_u32 s59, s59, 2752
    buffer_load_dwordx4 v[152:155], v17, s[44:47], s59 offen nt
    s_add_u32 s59, s59, 2752
    buffer_load_dwordx4 v[156:159], v17, s[44:47], s59 offen nt
    s_add_u32 s59, s59, 2752
    buffer_load_dwordx4 v[160:163], v17, s[44:47], s59 offen nt
    s_add_u32 s59, s59, 2752
    buffer_load_dwordx4 v[164:167], v17, s[44:47], s59 offen nt
    s_add_u32 s59, s59, 2752
    buffer_load_dwordx4 v[168:171], v17, s[44:47], s59 offen nt
    s_add_u32 s59, s59, 2752
    buffer_load_dwordx4 v[172:175], v17, s[44:47], s59 offen nt
    s_add_u32 s59, s59, 2752
    buffer_load_dwordx4 v[176:179], v17, s[44:47], s59 offen nt
    s_cmp_ge_u32 s31, 176
    s_cbranch_scc1 L_A0_noffn1
    s_lshl_b32 s56, s61, 8
    v_add_u32 v18, s56, v15
    ds_read_b128 v[36:39], v18 offset:0
    ds_read_b128 v[40:43], v18 offset:16
    ds_read_b128 v[44:47], v18 offset:32
    ds_read_b128 v[48:51], v18 offset:48
    s_waitcnt lgkmcnt(0)
    v_and_b32 v28, v36, v4
    v_and_b32 v29, v36, v5
    v_and_b32 v30, v36, v6
    v_and_b32 v31, v36, v7
    v_and_b32 v32, v37, v4
    v_and_b32 v33, v37, v5
    v_and_b32 v34, v37, v6
    v_and_b32 v35, v37, v7
    s_waitcnt vmcnt(0)
    v_mfma_f32_16x16x32_bf16 v[24:27], v[116:119], v[28:31], 0
    v_and_b32 v28, v38, v4
    v_and_b32 v29, v38, v5
    v_and_b32 v30, v38, v6
    v_and_b32 v31, v38, v7
    v_mfma_f32_16x16x32_bf16 v[24:27], v[120:123], v[32:35], v[24:27]
    v_and_b32 v32, v39, v4
    v_and_b32 v33, v39, v5
    v_and_b32 v34, v39, v6
    v_and_b32 v35, v39, v7
    v_mfma_f32_16x16x32_bf16 v[24:27], v[124:127], v[28:31], v[24:27]
    v_and_b32 v28, v40, v4
    v_and_b32 v29, v40, v5
    v_and_b32 v30, v40, v6
    v_and_b32 v31, v40, v7
    v_mfma_f32_16x16x32_bf16 v[24:27], v[128:131], v[32:35], v[24:27]
    v_and_b32 v32, v41, v4
    v_and_b32 v33, v41, v5
    v_and_b32 v34, v41, v6
    v_and_b32 v35, v41, v7
    v_mfma_f32_16x16x32_bf16 v[24:27], v[132:135], v[28:31], v[24:27]
    v_and_b32 v28, v42, v4
    v_and_b32 v29, v42, v5
    v_and_b32 v30, v42, v6
    v_and_b32 v31, v42, v7
    v_mfma_f32_16x16x32_bf16 v[24:27], v[136:139], v[32:35], v[24:27]
    v_and_b32 v32, v43, v4
    v_and_b32 v33, v43, v5
    v_and_b32 v34, v43, v6
    v_and_b32 v35, v43, v7
    v_mfma_f32_16x16x32_bf16 v[24:27], v[140:143], v[28:31], v[24:27]
    v_and_b32 v28, v44, v4
    v_and_b32 v29, v44, v5
    v_and_b32 v30, v44, v6
    v_and_b32 v31, v44, v7
    v_mfma_f32_16x16x32_bf16 v[24:27], v[144:147], v[32:35], v[24:27]
    v_and_b32 v32, v45, v4
    v_and_b32 v33, v45, v5
    v_and_b32 v34, v45, v6
    v_and_b32 v35, v45, v7
    v_mfma_f32_16x16x32_bf16 v[24:27], v[148:151], v[28:31], v[24:27]
    v_and_b32 v28, v46, v4
    v_and_b32 v29, v46, v5
    v_and_b32 v30, v46, v6
    v_and_b32 v31, v46, v7
    v_mfma_f32_16x16x32_bf16 v[24:27], v[152:155], v[32:35], v[24:27]
    v_and_b32 v32, v47, v4
    v_and_b32 v33, v47, v5
    v_and_b32 v34, v47, v6
    v_and_b32 v35, v47, v7
    v_mfma_f32_16x16x32_bf16 v[24:27], v[156:159], v[28:31], v[24:27]
    v_and_b32 v28, v48, v4
    v_and_b32 v29, v48, v5
    v_and_b32 v30, v48, v6
    v_and_b32 v31, v48, v7
    v_mfma_f32_16x16x32_bf16 v[24:27], v[160:163], v[32:35], v[24:27]
    v_and_b32 v32, v49, v4
    v_and_b32 v33, v49, v5
    v_and_b32 v34, v49, v6
    v_and_b32 v35, v49, v7
    v_mfma_f32_16x16x32_bf16 v[24:27], v[164:167], v[28:31], v[24:27]
    v_and_b32 v28, v50, v4
    v_and_b32 v29, v50, v5
    v_and_b32 v30, v50, v6
    v_and_b32 v31, v50, v7
    v_mfma_f32_16x16x32_bf16 v[24:27], v[168:171], v[32:35], v[24:27]
    v_and_b32 v32, v51, v4
    v_and_b32 v33, v51, v5
    v_and_b32 v34, v51, v6
    v_and_b32 v35, v51, v7
    v_mfma_f32_16x16x32_bf16 v[24:27], v[172:175], v[28:31], v[24:27]
    s_nop 0
    v_mfma_f32_16x16x32_bf16 v[24:27], v[176:179], v[32:35], v[24:27]
    s_lshl_b32 s56, s31, 10
    s_add_u32 s56, s56, 262144
    s_nop 5
    v_bfi_b32 v24, 7, v245, v24
    v_bfi_b32 v25, 7, v245, v25
    v_bfi_b32 v26, 7, v245, v26
    v_bfi_b32 v27, 7, v245, v27
    buffer_store_dwordx4 v[24:27], v16, s[48:51], s56 offen offset:0 sc1
L_A0_noffn1:
    s_setprio 0
    s_cmp_ge_u32 s31, 32
    s_cbranch_scc1 L_A0_nogen
    s_lshr_b32 s60, s31, 3
    s_and_b32 s61, s31, 7
    s_and_b32 s56, s61, 1
    s_lshl_b32 s56, s56, 9
    s_lshl_b32 s57, s60, 7
    s_add_u32 s56, s56, s57
    s_lshr_b32 s57, s61, 1
    s_lshl_b32 s57, s57, 5
    s_add_u32 s56, s56, s57
    v_and_b32 v8, 31, v1
    v_add_u32 v8, s56, v8
    v_lshlrev_b32 v19, 1, v8
    buffer_load_ushort v11, v19, s[36:39], 0 offen
    v_lshrrev_b32 v8, 3, v1
    v_lshlrev_b32 v17, 12, v8
    v_and_b32 v18, 3, v8
    v_and_b32 v8, 7, v1
    v_lshl_add_u32 v17, v8, 4, v17
    s_lshl_b32 s60, s60, 10
    s_lshl_b32 s61, s61, 7
    s_add_u32 s60, s60, s61
    s_add_u32 s61, s60, 786432
    v_mov_b32 v60, 0
    v_mov_b32 v61, 0
    v_mov_b32 v62, 0
    v_mov_b32 v63, 0
    s_sleep 64
    s_sleep 64
    s_sleep 64
    s_mov_b32 s62, 0x40000
    s_mov_b32 s86, 7
L_dp_3:
    s_mov_b32 s57, s61
    s_bitcmp1_b32 s86, 0
    s_cbranch_scc0 L_dps_5
    buffer_load_dwordx4 v[52:55], v17, s[48:51], s57 offen offset:0 sc1
L_dps_5:
    s_add_u32 s57, s57, 32768
    s_bitcmp1_b32 s86, 1
    s_cbranch_scc0 L_dps_6
    buffer_load_dwordx4 v[56:59], v17, s[48:51], s57 offen offset:0 sc1
L_dps_6:
    s_add_u32 s57, s57, 32768
    s_bitcmp1_b32 s86, 2
    s_cbranch_scc0 L_dps_7
    s_mov_b32 exec_hi, 0xffff
    buffer_load_dwordx4 v[60:63], v17, s[48:51], s57 offen offset:0 sc1
    s_mov_b32 exec_hi, -1
L_dps_7:
    s_waitcnt vmcnt(0)
    s_bitcmp1_b32 s86, 0
    s_cbranch_scc0 L_dpc_8
    v_xor_b32 v52, v52, v245
    v_xor_b32 v53, v53, v245
    v_xor_b32 v54, v54, v245
    v_xor_b32 v55, v55, v245
    v_or3_b32 v8, v52, v53, v54
    v_or_b32 v8, v8, v55
    v_and_b32 v8, 7, v8
    v_cmp_ne_u32 vcc, 0, v8
    s_cbranch_vccnz L_dpc_8
    s_bitset0_b32 s86, 0
L_dpc_8:
    s_bitcmp1_b32 s86, 1
    s_cbranch_scc0 L_dpc_9
    v_xor_b32 v56, v56, v245
    v_xor_b32 v57, v57, v245
    v_xor_b32 v58, v58, v245
    v_xor_b32 v59, v59, v245
    v_or3_b32 v8, v56, v57, v58
    v_or_b32 v8, v8, v59
    v_and_b32 v8, 7, v8
    v_cmp_ne_u32 vcc, 0, v8
    s_cbranch_vccnz L_dpc_9
    s_bitset0_b32 s86, 1
L_dpc_9:
    s_bitcmp1_b32 s86, 2
    s_cbranch_scc0 L_dpc_10
    s_mov_b32 exec_hi, 0xffff
    v_xor_b32 v60, v60, v245
    v_xor_b32 v61, v61, v245
    v_xor_b32 v62, v62, v245
    v_xor_b32 v63, v63, v245
    v_or3_b32 v8, v60, v61, v62
    v_or_b32 v8, v8, v63
    v_and_b32 v8, 7, v8
    v_cmp_ne_u32 vcc, 0, v8
    s_mov_b32 exec_hi, -1
    s_cbranch_vccnz L_dpc_10
    s_bitset0_b32 s86, 2
L_dpc_10:
    s_cmp_eq_u32 s86, 0
    s_cbranch_scc1 L_dpd_4
    s_sub_u32 s62, s62, 1
    s_cbranch_scc1 L_dpd_4
    s_sleep 64
    s_branch L_dp_3
L_dpd_4:
    v_cmp_eq_u32 s[96:97], 1, v18
    v_cmp_eq_u32 s[98:99], 2, v18
    v_cmp_eq_u32 s[100:101], 3, v18
    v_add_f32 v52, v52, v56
    v_add_f32 v53, v53, v57
    v_add_f32 v54, v54, v58
    v_add_f32 v55, v55, v59
    v_add_f32 v52, v52, v60
    v_add_f32 v53, v53, v61
    v_add_f32 v54, v54, v62
    v_add_f32 v55, v55, v63
    v_add_f32_dpp v52, v52, v52 row_ror:8 row_mask:0xf bank_mask:0xf
    v_add_f32_dpp v53, v53, v53 row_ror:8 row_mask:0xf bank_mask:0xf
    v_add_f32_dpp v54, v54, v54 row_ror:8 row_mask:0xf bank_mask:0xf
    v_add_f32_dpp v55, v55, v55 row_ror:8 row_mask:0xf bank_mask:0xf
    v_mov_b32 v56, v52
    v_mov_b32 v57, v53
    v_mov_b32 v58, v54
    v_mov_b32 v59, v55
    v_permlane16_swap_b32 v52, v56
    v_permlane16_swap_b32 v53, v57
    v_permlane16_swap_b32 v54, v58
    v_permlane16_swap_b32 v55, v59
    v_add_f32 v52, v52, v56
    v_add_f32 v53, v53, v57
    v_add_f32 v54, v54, v58
    v_add_f32 v55, v55, v59
    v_mov_b32 v56, v52
    v_mov_b32 v57, v53
    v_mov_b32 v58, v54
    v_mov_b32 v59, v55
    v_permlane32_swap_b32 v52, v56
    v_permlane32_swap_b32 v53, v57
    v_permlane32_swap_b32 v54, v58
    v_permlane32_swap_b32 v55, v59
    v_add_f32 v52, v52, v56
    v_add_f32 v53, v53, v57
    v_add_f32 v54, v54, v58
    v_add_f32 v55, v55, v59
    v_cndmask_b32 v12, v52, v53, s[96:97]
    v_cndmask_b32 v12, v12, v54, s[98:99]
    v_cndmask_b32 v12, v12, v55, s[100:101]
    v_cvt_pk_bf16_f32 v12, v12, v12
    v_and_b32 v12, 0xffff0000, v12
    v_mul_f32 v9, 0xbfb8aa3b, v12
    v_exp_f32 v9, v9
    s_nop 0
    v_add_f32 v9, 1.0, v9
    v_rcp_f32 v9, v9
    s_nop 0
    v_mul_f32 v12, v12, v9
    v_cvt_pk_bf16_f32 v12, v12, v12
    v_and_b32 v12, 0xffff0000, v12
    v_lshlrev_b32 v11, 16, v11
    s_mov_b32 s40, s22
    s_and_b32 s41, s23, 0xffff
    s_mov_b32 s42, 0x800
    s_mov_b32 s43, 0x20000
    s_lshl_b32 s60, s31, 13
    s_add_u32 s60, s60, 0x100000
    s_mov_b32 s95, 1
    s_branch L_A0_dry0
L_A0_real:
    s_mov_b32 s95, 0
    s_setprio 3
    s_barrier
    s_mov_b32 s62, 0x40000
    s_mov_b32 s86, 255
    s_add_u32 s87, s60, 0
    s_add_u32 s88, s60, 1024
    s_add_u32 s89, s60, 2048
    s_add_u32 s90, s60, 3072
    s_add_u32 s91, s60, 4096
    s_add_u32 s92, s60, 5120
    s_add_u32 s93, s60, 6144
    s_add_u32 s94, s60, 7168
    buffer_load_dwordx4 v[116:119], v16, s[48:51], s87 offen offset:0 sc1
    buffer_load_dwordx4 v[120:123], v16, s[48:51], s88 offen offset:0 sc1
    buffer_load_dwordx4 v[124:127], v16, s[48:51], s89 offen offset:0 sc1
    buffer_load_dwordx4 v[128:131], v16, s[48:51], s90 offen offset:0 sc1
    buffer_load_dwordx4 v[132:135], v16, s[48:51], s91 offen offset:0 sc1
    buffer_load_dwordx4 v[136:139], v16, s[48:51], s92 offen offset:0 sc1
    buffer_load_dwordx4 v[140:143], v16, s[48:51], s93 offen offset:0 sc1
    buffer_load_dwordx4 v[144:147], v16, s[48:51], s94 offen offset:0 sc1
    s_sleep 8
L_yp_11:
    buffer_load_dwordx4 v[148:151], v16, s[48:51], s87 offen offset:0 sc1
    buffer_load_dwordx4 v[152:155], v16, s[48:51], s88 offen offset:0 sc1
    buffer_load_dwordx4 v[156:159], v16, s[48:51], s89 offen offset:0 sc1
    buffer_load_dwordx4 v[160:163], v16, s[48:51], s90 offen offset:0 sc1
    buffer_load_dwordx4 v[164:167], v16, s[48:51], s91 offen offset:0 sc1
    buffer_load_dwordx4 v[168:171], v16, s[48:51], s92 offen offset:0 sc1
    buffer_load_dwordx4 v[172:175], v16, s[48:51], s93 offen offset:0 sc1
    buffer_load_dwordx4 v[176:179], v16, s[48:51], s94 offen offset:0 sc1
    s_waitcnt vmcnt(8)
    s_bitcmp1_b32 s86, 0
    s_cbranch_scc0 L_ypc_13
    v_xor_b32 v52, v116, v245
    v_xor_b32 v53, v117, v245
    v_xor_b32 v54, v118, v245
    v_xor_b32 v55, v119, v245
    v_or3_b32 v8, v52, v53, v54
    v_or_b32 v8, v8, v55
    v_and_b32 v8, 7, v8
    v_cmp_ne_u32 vcc, 0, v8
    s_cbranch_vccnz L_ypc_13
    s_bitset0_b32 s86, 0
    s_mov_b32 s87, 0x40000000
L_ypc_13:
    s_bitcmp1_b32 s86, 1
    s_cbranch_scc0 L_ypc_14
    v_xor_b32 v56, v120, v245
    v_xor_b32 v57, v121, v245
    v_xor_b32 v58, v122, v245
    v_xor_b32 v59, v123, v245
    v_or3_b32 v8, v56, v57, v58
    v_or_b32 v8, v8, v59
    v_and_b32 v8, 7, v8
    v_cmp_ne_u32 vcc, 0, v8
    s_cbranch_vccnz L_ypc_14
    s_bitset0_b32 s86, 1
    s_mov_b32 s88, 0x40000000
L_ypc_14:
    s_bitcmp1_b32 s86, 2
    s_cbranch_scc0 L_ypc_15
    v_xor_b32 v60, v124, v245
    v_xor_b32 v61, v125, v245
    v_xor_b32 v62, v126, v245
    v_xor_b32 v63, v127, v245
    v_or3_b32 v8, v60, v61, v62
    v_or_b32 v8, v8, v63
    v_and_b32 v8, 7, v8
    v_cmp_ne_u32 vcc, 0, v8
    s_cbranch_vccnz L_ypc_15
    s_bitset0_b32 s86, 2
    s_mov_b32 s89, 0x40000000
L_ypc_15:
    s_bitcmp1_b32 s86, 3
    s_cbranch_scc0 L_ypc_16
    v_xor_b32 v64, v128, v245
    v_xor_b32 v65, v129, v245
    v_xor_b32 v66, v130, v245
    v_xor_b32 v67, v131, v245
    v_or3_b32 v8, v64, v65, v66
    v_or_b32 v8, v8, v67
    v_and_b32 v8, 7, v8
    v_cmp_ne_u32 vcc, 0, v8
    s_cbranch_vccnz L_ypc_16
    s_bitset0_b32 s86, 3
    s_mov_b32 s90, 0x40000000
L_ypc_16:
    s_bitcmp1_b32 s86, 4
    s_cbranch_scc0 L_ypc_17
    v_xor_b32 v68, v132, v245
    v_xor_b32 v69, v133, v245
    v_xor_b32 v70, v134, v245
    v_xor_b32 v71, v135, v245
    v_or3_b32 v8, v68, v69, v70
    v_or_b32 v8, v8, v71
    v_and_b32 v8, 7, v8
    v_cmp_ne_u32 vcc, 0, v8
    s_cbranch_vccnz L_ypc_17
    s_bitset0_b32 s86, 4
    s_mov_b32 s91, 0x40000000
L_ypc_17:
    s_bitcmp1_b32 s86, 5
    s_cbranch_scc0 L_ypc_18
    v_xor_b32 v72, v136, v245
    v_xor_b32 v73, v137, v245
    v_xor_b32 v74, v138, v245
    v_xor_b32 v75, v139, v245
    v_or3_b32 v8, v72, v73, v74
    v_or_b32 v8, v8, v75
    v_and_b32 v8, 7, v8
    v_cmp_ne_u32 vcc, 0, v8
    s_cbranch_vccnz L_ypc_18
    s_bitset0_b32 s86, 5
    s_mov_b32 s92, 0x40000000
L_ypc_18:
    s_bitcmp1_b32 s86, 6
    s_cbranch_scc0 L_ypc_19
    v_xor_b32 v76, v140, v245
    v_xor_b32 v77, v141, v245
    v_xor_b32 v78, v142, v245
    v_xor_b32 v79, v143, v245
    v_or3_b32 v8, v76, v77, v78
    v_or_b32 v8, v8, v79
    v_and_b32 v8, 7, v8
    v_cmp_ne_u32 vcc, 0, v8
    s_cbranch_vccnz L_ypc_19
    s_bitset0_b32 s86, 6
    s_mov_b32 s93, 0x40000000
L_ypc_19:
    s_bitcmp1_b32 s86, 7
    s_cbranch_scc0 L_ypc_20
    v_xor_b32 v80, v144, v245
    v_xor_b32 v81, v145, v245
    v_xor_b32 v82, v146, v245
    v_xor_b32 v83, v147, v245
    v_or3_b32 v8, v80, v81, v82
    v_or_b32 v8, v8, v83
    v_and_b32 v8, 7, v8
    v_cmp_ne_u32 vcc, 0, v8
    s_cbranch_vccnz L_ypc_20
    s_bitset0_b32 s86, 7
    s_mov_b32 s94, 0x40000000
L_ypc_20:
    s_cmp_eq_u32 s86, 0
    s_cbranch_scc1 L_ypd_12
    buffer_load_dwordx4 v[116:119], v16, s[48:51], s87 offen offset:0 sc1
    buffer_load_dwordx4 v[120:123], v16, s[48:51], s88 offen offset:0 sc1
    buffer_load_dwordx4 v[124:127], v16, s[48:51], s89 offen offset:0 sc1
    buffer_load_dwordx4 v[128:131], v16, s[48:51], s90 offen offset:0 sc1
    buffer_load_dwordx4 v[132:135], v16, s[48:51], s91 offen offset:0 sc1
    buffer_load_dwordx4 v[136:139], v16, s[48:51], s92 offen offset:0 sc1
    buffer_load_dwordx4 v[140:143], v16, s[48:51], s93 offen offset:0 sc1
    buffer_load_dwordx4 v[144:147], v16, s[48:51], s94 offen offset:0 sc1
    s_waitcnt vmcnt(8)
    s_bitcmp1_b32 s86, 0
    s_cbranch_scc0 L_ypc_21
    v_xor_b32 v52, v148, v245
    v_xor_b32 v53, v149, v245
    v_xor_b32 v54, v150, v245
    v_xor_b32 v55, v151, v245
    v_or3_b32 v8, v52, v53, v54
    v_or_b32 v8, v8, v55
    v_and_b32 v8, 7, v8
    v_cmp_ne_u32 vcc, 0, v8
    s_cbranch_vccnz L_ypc_21
    s_bitset0_b32 s86, 0
    s_mov_b32 s87, 0x40000000
L_ypc_21:
    s_bitcmp1_b32 s86, 1
    s_cbranch_scc0 L_ypc_22
    v_xor_b32 v56, v152, v245
    v_xor_b32 v57, v153, v245
    v_xor_b32 v58, v154, v245
    v_xor_b32 v59, v155, v245
    v_or3_b32 v8, v56, v57, v58
    v_or_b32 v8, v8, v59
    v_and_b32 v8, 7, v8
    v_cmp_ne_u32 vcc, 0, v8
    s_cbranch_vccnz L_ypc_22
    s_bitset0_b32 s86, 1
    s_mov_b32 s88, 0x40000000
L_ypc_22:
    s_bitcmp1_b32 s86, 2
    s_cbranch_scc0 L_ypc_23
    v_xor_b32 v60, v156, v245
    v_xor_b32 v61, v157, v245
    v_xor_b32 v62, v158, v245
    v_xor_b32 v63, v159, v245
    v_or3_b32 v8, v60, v61, v62
    v_or_b32 v8, v8, v63
    v_and_b32 v8, 7, v8
    v_cmp_ne_u32 vcc, 0, v8
    s_cbranch_vccnz L_ypc_23
    s_bitset0_b32 s86, 2
    s_mov_b32 s89, 0x40000000
L_ypc_23:
    s_bitcmp1_b32 s86, 3
    s_cbranch_scc0 L_ypc_24
    v_xor_b32 v64, v160, v245
    v_xor_b32 v65, v161, v245
    v_xor_b32 v66, v162, v245
    v_xor_b32 v67, v163, v245
    v_or3_b32 v8, v64, v65, v66
    v_or_b32 v8, v8, v67
    v_and_b32 v8, 7, v8
    v_cmp_ne_u32 vcc, 0, v8
    s_cbranch_vccnz L_ypc_24
    s_bitset0_b32 s86, 3
    s_mov_b32 s90, 0x40000000
L_ypc_24:
    s_bitcmp1_b32 s86, 4
    s_cbranch_scc0 L_ypc_25
    v_xor_b32 v68, v164, v245
    v_xor_b32 v69, v165, v245
    v_xor_b32 v70, v166, v245
    v_xor_b32 v71, v167, v245
    v_or3_b32 v8, v68, v69, v70
    v_or_b32 v8, v8, v71
    v_and_b32 v8, 7, v8
    v_cmp_ne_u32 vcc, 0, v8
    s_cbranch_vccnz L_ypc_25
    s_bitset0_b32 s86, 4
    s_mov_b32 s91, 0x40000000
L_ypc_25:
    s_bitcmp1_b32 s86, 5
    s_cbranch_scc0 L_ypc_26
    v_xor_b32 v72, v168, v245
    v_xor_b32 v73, v169, v245
    v_xor_b32 v74, v170, v245
    v_xor_b32 v75, v171, v245
    v_or3_b32 v8, v72, v73, v74
    v_or_b32 v8, v8, v75
    v_and_b32 v8, 7, v8
    v_cmp_ne_u32 vcc, 0, v8
    s_cbranch_vccnz L_ypc_26
    s_bitset0_b32 s86, 5
    s_mov_b32 s92, 0x40000000
L_ypc_26:
    s_bitcmp1_b32 s86, 6
    s_cbranch_scc0 L_ypc_27
    v_xor_b32 v76, v172, v245
    v_xor_b32 v77, v173, v245
    v_xor_b32 v78, v174, v245
    v_xor_b32 v79, v175, v245
    v_or3_b32 v8, v76, v77, v78
    v_or_b32 v8, v8, v79
    v_and_b32 v8, 7, v8
    v_cmp_ne_u32 vcc, 0, v8
    s_cbranch_vccnz L_ypc_27
    s_bitset0_b32 s86, 6
    s_mov_b32 s93, 0x40000000
L_ypc_27:
    s_bitcmp1_b32 s86, 7
    s_cbranch_scc0 L_ypc_28
    v_xor_b32 v80, v176, v245
    v_xor_b32 v81, v177, v245
    v_xor_b32 v82, v178, v245
    v_xor_b32 v83, v179, v245
    v_or3_b32 v8, v80, v81, v82
    v_or_b32 v8, v8, v83
    v_and_b32 v8, 7, v8
    v_cmp_ne_u32 vcc, 0, v8
    s_cbranch_vccnz L_ypc_28
    s_bitset0_b32 s86, 7
    s_mov_b32 s94, 0x40000000
L_ypc_28:
    s_cmp_eq_u32 s86, 0
    s_cbranch_scc1 L_ypd_12
    s_sub_u32 s62, s62, 1
    s_cbranch_scc0 L_yp_11
L_ypd_12:
L_A0_dry0:
    v_add_f32 v52, v52, v56
    v_add_f32 v53, v53, v57
    v_add_f32 v54, v54, v58
    v_add_f32 v55, v55, v59
    v_add_f32 v52, v52, v60
    v_add_f32 v53, v53, v61
    v_add_f32 v54, v54, v62
    v_add_f32 v55, v55, v63
    v_add_f32 v52, v52, v64
    v_add_f32 v53, v53, v65
    v_add_f32 v54, v54, v66
    v_add_f32 v55, v55, v67
    v_add_f32 v52, v52, v68
    v_add_f32 v53, v53, v69
    v_add_f32 v54, v54, v70
    v_add_f32 v55, v55, v71
    v_add_f32 v52, v52, v72
    v_add_f32 v53, v53, v73
    v_add_f32 v54, v54, v74
    v_add_f32 v55, v55, v75
    v_add_f32 v52, v52, v76
    v_add_f32 v53, v53, v77
    v_add_f32 v54, v54, v78
    v_add_f32 v55, v55, v79
    v_add_f32 v52, v52, v80
    v_add_f32 v53, v53, v81
    v_add_f32 v54, v54, v82
    v_add_f32 v55, v55, v83
    v_add_f32_dpp v52, v52, v52 row_ror:8 row_mask:0xf bank_mask:0xf
    v_add_f32_dpp v53, v53, v53 row_ror:8 row_mask:0xf bank_mask:0xf
    v_add_f32_dpp v54, v54, v54 row_ror:8 row_mask:0xf bank_mask:0xf
    v_add_f32_dpp v55, v55, v55 row_ror:8 row_mask:0xf bank_mask:0xf
    v_mov_b32 v56, v52
    v_mov_b32 v57, v53
    v_mov_b32 v58, v54
    v_mov_b32 v59, v55
    v_permlane16_swap_b32 v52, v56
    v_permlane16_swap_b32 v53, v57
    v_permlane16_swap_b32 v54, v58
    v_permlane16_swap_b32 v55, v59
    v_add_f32 v52, v52, v56
    v_add_f32 v53, v53, v57
    v_add_f32 v54, v54, v58
    v_add_f32 v55, v55, v59
    v_mov_b32 v56, v52
    v_mov_b32 v57, v53
    v_mov_b32 v58, v54
    v_mov_b32 v59, v55
    v_permlane32_swap_b32 v52, v56
    v_permlane32_swap_b32 v53, v57
    v_permlane32_swap_b32 v54, v58
    v_permlane32_swap_b32 v55, v59
    v_add_f32 v52, v52, v56
    v_add_f32 v53, v53, v57
    v_add_f32 v54, v54, v58
    v_add_f32 v55, v55, v59
    v_cndmask_b32 v14, v52, v53, s[96:97]
    v_cndmask_b32 v14, v14, v54, s[98:99]
    v_cndmask_b32 v14, v14, v55, s[100:101]
    v_cvt_pk_bf16_f32 v14, v14, v14
    v_and_b32 v14, 0xffff0000, v14
    v_mul_f32 v14, v14, v12
    v_cvt_pk_bf16_f32 v14, v14, v14
    v_and_b32 v14, 0xffff0000, v14
    v_add_f32 v14, v14, v11
    v_cvt_pk_bf16_f32 v14, v14, v14
    s_cmp_lg_u32 s95, 0
    s_cbranch_scc1 L_A0_real
    s_mov_b32 exec_hi, 0
    buffer_store_short v14, v19, s[40:43], 0 offen
L_A0_stored:
    s_cmp_lg_u32 s31, 0
    s_cbranch_scc1 L_A0_nogen
    s_mov_b64 exec, 1
    v_mov_b32 v8, s35
    v_mov_b32 v9, 0x140000
    buffer_store_dword v8, v9, s[48:51], 0 offen sc1
L_A0_nogen:
    s_endpgm
L_A1:
    s_setprio 2
    v_mov_b32 v245, 7
    v_mov_b32 v15, 0
    ds_write_b32 v15, v15 offset:6464
    ds_write_b32 v15, v15 offset:6468
    ds_write_b32 v15, v15 offset:6472
    v_and_b32 v8, 1, v1
    v_lshlrev_b32 v8, 4, v8
    v_mov_b32 v9, 0xffff
    v_lshlrev_b32 v9, v8, v9
    v_bfe_u32 v8, v1, 1, 2
    v_cmp_eq_u32 vcc, 0, v8
    s_nop 1
    v_cndmask_b32 v4, 0, v9, vcc
    v_cmp_eq_u32 vcc, 1, v8
    s_nop 1
    v_cndmask_b32 v5, 0, v9, vcc
    v_cmp_eq_u32 vcc, 2, v8
    s_nop 1
    v_cndmask_b32 v6, 0, v9, vcc
    v_cmp_eq_u32 vcc, 3, v8
    s_nop 1
    v_cndmask_b32 v7, 0, v9, vcc
    s_lshl_b32 s63, s31, 10
    s_add_u32 s63, s63, 524288
    v_lshlrev_b32 v17, 14, v3
    v_lshl_add_u32 v17, v2, 4, v17
    s_lshl_b32 s56, s28, 17
    s_lshl_b32 s57, s29, 16
    s_add_u32 s56, s56, s57
    s_lshl_b32 s57, s30, 8
    s_add_u32 s56, s56, s57
    v_lshrrev_b32 v8, 5, v1
    v_lshlrev_b32 v18, 10, v8
    v_bfe_u32 v8, v1, 3, 2
    v_lshl_add_u32 v18, v8, 8, v18
    v_lshlrev_b32 v19, 6, v8
    v_and_b32 v8, 7, v1
    v_lshl_add_u32 v18, v8, 4, v18
    v_lshl_add_u32 v19, v8, 1, v19
    s_lshr_b32 s57, s31, 4
    s_add_u32 s57, s57, 80
    s_and_b32 s58, s31, 0x8f
    s_cmp_eq_u32 s58, 9
    s_cselect_b32 s69, s57, 255
    s_sub_u32 s57, s31, 176
    s_cmp_ge_u32 s31, 176
    s_cselect_b32 s69, s57, s69
    s_mov_b32 s57, s69
    s_lshr_b32 s60, s57, 2
    s_and_b32 s61, s57, 3
    s_lshl_b32 s59, s60, 16
    s_lshl_b32 s57, s61, 8
    s_add_u32 s59, s59, s57
    s_waitcnt lgkmcnt(0)
    s_mov_b32 s48, s26
    s_and_b32 s49, s27, 0xffff
    s_mov_b32 s50, 0x200000
    s_mov_b32 s51, 0x20000
    s_mov_b32 s58, 0x140000
    s_load_dword s34, s[26:27], s58
    s_mov_b32 s40, s12
    s_and_b32 s41, s13, 0xffff
    s_mov_b32 s42, 0x400000
    s_mov_b32 s43, 0x20000
    s_barrier
    s_waitcnt lgkmcnt(0)
    s_add_u32 s35, s34, 1
    v_and_b32 v245, s35, v245
    s_mov_b32 s68, s56
    v_mov_b32 v246, v17
    s_mov_b32 s44, s20
    s_and_b32 s45, s21, 0xffff
    s_mov_b32 s46, 0x158000
    s_mov_b32 s47, 0x20000
    s_cmp_lt_u32 s69, 88
    s_cselect_b32 s46, 1409024, 0
    buffer_load_dwordx4 v[116:119], v17, s[44:47], s59 offen offset:0 nt
    buffer_load_dwordx4 v[120:123], v17, s[44:47], s59 offen offset:1024 nt
    buffer_load_dwordx4 v[124:127], v17, s[44:47], s59 offen offset:2048 nt
    buffer_load_dwordx4 v[128:131], v17, s[44:47], s59 offen offset:3072 nt
    s_add_u32 s59, s59, 4096
    buffer_load_dwordx4 v[132:135], v17, s[44:47], s59 offen offset:0 nt
    buffer_load_dwordx4 v[136:139], v17, s[44:47], s59 offen offset:1024 nt
    buffer_load_dwordx4 v[140:143], v17, s[44:47], s59 offen offset:2048 nt
    buffer_load_dwordx4 v[144:147], v17, s[44:47], s59 offen offset:3072 nt
    s_add_u32 s59, s59, 4096
    buffer_load_dwordx4 v[148:151], v17, s[44:47], s59 offen offset:0 nt
    buffer_load_dwordx4 v[152:155], v17, s[44:47], s59 offen offset:1024 nt
    buffer_load_dwordx4 v[156:159], v17, s[44:47], s59 offen offset:2048 nt
    buffer_load_dwordx4 v[160:163], v17, s[44:47], s59 offen offset:3072 nt
    s_add_u32 s59, s59, 4096
    buffer_load_dwordx4 v[164:167], v17, s[44:47], s59 offen offset:0 nt
    buffer_load_dwordx4 v[168:171], v17, s[44:47], s59 offen offset:1024 nt
    buffer_load_dwordx4 v[172:175], v17, s[44:47], s59 offen offset:2048 nt
    buffer_load_dwordx4 v[176:179], v17, s[44:47], s59 offen offset:3072 nt
    s_lshl_b32 s56, s28, 13
    s_lshl_b32 s57, s29, 7
    s_add_u32 s56, s56, s57
    s_barrier
    s_sleep 12
    s_mov_b32 s62, 0x40000
    s_mov_b32 s86, 15
L_qp_29:
    s_mov_b32 s57, s56
    s_bitcmp1_b32 s86, 0
    s_cbranch_scc0 L_qps_31
    buffer_load_dwordx4 v[180:183], v18, s[48:51], s57 offen offset:0 sc1
L_qps_31:
    s_add_u32 s57, s57, 2048
    s_bitcmp1_b32 s86, 1
    s_cbranch_scc0 L_qps_32
    buffer_load_dwordx4 v[184:187], v18, s[48:51], s57 offen offset:0 sc1
L_qps_32:
    s_add_u32 s57, s57, 2048
    s_bitcmp1_b32 s86, 2
    s_cbranch_scc0 L_qps_33
    buffer_load_dwordx4 v[188:191], v18, s[48:51], s57 offen offset:0 sc1
L_qps_33:
    s_add_u32 s57, s57, 2048
    s_bitcmp1_b32 s86, 3
    s_cbranch_scc0 L_qps_34
    buffer_load_dwordx4 v[192:195], v18, s[48:51], s57 offen offset:0 sc1
L_qps_34:
    s_waitcnt vmcnt(0)
    s_bitcmp1_b32 s86, 0
    s_cbranch_scc0 L_qpc_35
    v_xor_b32 v180, v180, v245
    v_xor_b32 v181, v181, v245
    v_xor_b32 v182, v182, v245
    v_xor_b32 v183, v183, v245
    v_or3_b32 v8, v180, v181, v182
    v_or_b32 v8, v8, v183
    v_and_b32 v8, 7, v8
    v_cmp_ne_u32 vcc, 0, v8
    s_cbranch_vccnz L_qpc_35
    s_bitset0_b32 s86, 0
L_qpc_35:
    s_bitcmp1_b32 s86, 1
    s_cbranch_scc0 L_qpc_36
    v_xor_b32 v184, v184, v245
    v_xor_b32 v185, v185, v245
    v_xor_b32 v186, v186, v245
    v_xor_b32 v187, v187, v245
    v_or3_b32 v8, v184, v185, v186
    v_or_b32 v8, v8, v187
    v_and_b32 v8, 7, v8
    v_cmp_ne_u32 vcc, 0, v8
    s_cbranch_vccnz L_qpc_36
    s_bitset0_b32 s86, 1
L_qpc_36:
    s_bitcmp1_b32 s86, 2
    s_cbranch_scc0 L_qpc_37
    v_xor_b32 v188, v188, v245
    v_xor_b32 v189, v189, v245
    v_xor_b32 v190, v190, v245
    v_xor_b32 v191, v191, v245
    v_or3_b32 v8, v188, v189, v190
    v_or_b32 v8, v8, v191
    v_and_b32 v8, 7, v8
    v_cmp_ne_u32 vcc, 0, v8
    s_cbranch_vccnz L_qpc_37
    s_bitset0_b32 s86, 2
L_qpc_37:
    s_bitcmp1_b32 s86, 3
    s_cbranch_scc0 L_qpc_38
    v_xor_b32 v192, v192, v245
    v_xor_b32 v193, v193, v245
    v_xor_b32 v194, v194, v245
    v_xor_b32 v195, v195, v245
    v_or3_b32 v8, v192, v193, v194
    v_or_b32 v8, v8, v195
    v_and_b32 v8, 7, v8
    v_cmp_ne_u32 vcc, 0, v8
    s_cbranch_vccnz L_qpc_38
    s_bitset0_b32 s86, 3
L_qpc_38:
    s_cmp_eq_u32 s86, 0
    s_cbranch_scc1 L_qpd_30
    s_sub_u32 s62, s62, 1
    s_cbranch_scc1 L_qpd_30
    s_sleep 1
    s_branch L_qp_29
L_qpd_30:
    v_add_f32 v180, v180, v184
    v_add_f32 v181, v181, v185
    v_add_f32 v182, v182, v186
    v_add_f32 v183, v183, v187
    v_add_f32 v180, v180, v188
    v_add_f32 v181, v181, v189
    v_add_f32 v182, v182, v190
    v_add_f32 v183, v183, v191
    v_add_f32 v180, v180, v192
    v_add_f32 v181, v181, v193
    v_add_f32 v182, v182, v194
    v_add_f32 v183, v183, v195
    v_mov_b32 v184, v180
    v_mov_b32 v185, v181
    v_mov_b32 v186, v182
    v_mov_b32 v187, v183
    v_permlane32_swap_b32 v180, v184
    v_permlane32_swap_b32 v181, v185
    v_permlane32_swap_b32 v182, v186
    v_permlane32_swap_b32 v183, v187
    v_add_f32 v180, v180, v184
    v_add_f32 v181, v181, v185
    v_add_f32 v182, v182, v186
    v_add_f32 v183, v183, v187
    v_cvt_pk_bf16_f32 v180, v180, v180
    v_cvt_pk_bf16_f32 v181, v181, v181
    v_cvt_pk_bf16_f32 v182, v182, v182
    v_cvt_pk_bf16_f32 v183, v183, v183
    ds_write_b16 v19, v180 offset:4096
    ds_write_b16 v19, v181 offset:4112
    ds_write_b16 v19, v182 offset:4128
    ds_write_b16 v19, v183 offset:4144
    v_mov_b32 v8, 1
    s_waitcnt lgkmcnt(0)
    ds_write_b32 v15, v8 offset:6464
    s_setprio 0
    v_lshrrev_b32 v8, 3, v2
    v_lshlrev_b32 v11, 8, v8
    v_lshl_add_u32 v11, v3, 6, v11
    v_lshlrev_b32 v14, 4, v1
    s_cmp_ge_u32 s69, 88
    s_cbranch_scc1 L_A1_noffn2
    v_lshrrev_b32 v8, 5, v1
    v_mul_u32_u24 v17, 90112, v8
    v_and_b32 v8, 31, v1
    v_lshl_add_u32 v17, v8, 4, v17
    s_lshr_b32 s56, s60, 1
    s_lshl_b32 s56, s56, 13
    s_add_u32 s56, s56, 262144
    s_and_b32 s57, s60, 1
    s_lshl_b32 s57, s57, 9
    s_add_u32 s56, s56, s57
    s_sleep 64
    s_mov_b32 s62, 0x40000
    s_mov_b32 s86, 255
L_gp_39:
    s_mov_b32 s57, s56
    s_bitcmp1_b32 s86, 0
    s_cbranch_scc0 L_gps_41
    buffer_load_dwordx4 v[180:183], v17, s[48:51], s57 offen offset:0 sc1
L_gps_41:
    s_add_u32 s57, s57, 1024
    s_bitcmp1_b32 s86, 1
    s_cbranch_scc0 L_gps_42
    buffer_load_dwordx4 v[184:187], v17, s[48:51], s57 offen offset:0 sc1
L_gps_42:
    s_add_u32 s57, s57, 1024
    s_bitcmp1_b32 s86, 2
    s_cbranch_scc0 L_gps_43
    buffer_load_dwordx4 v[188:191], v17, s[48:51], s57 offen offset:0 sc1
L_gps_43:
    s_add_u32 s57, s57, 1024
    s_bitcmp1_b32 s86, 3
    s_cbranch_scc0 L_gps_44
    buffer_load_dwordx4 v[192:195], v17, s[48:51], s57 offen offset:0 sc1
L_gps_44:
    s_add_u32 s57, s57, 1024
    s_bitcmp1_b32 s86, 4
    s_cbranch_scc0 L_gps_45
    buffer_load_dwordx4 v[196:199], v17, s[48:51], s57 offen offset:0 sc1
L_gps_45:
    s_add_u32 s57, s57, 1024
    s_bitcmp1_b32 s86, 5
    s_cbranch_scc0 L_gps_46
    buffer_load_dwordx4 v[200:203], v17, s[48:51], s57 offen offset:0 sc1
L_gps_46:
    s_add_u32 s57, s57, 1024
    s_bitcmp1_b32 s86, 6
    s_cbranch_scc0 L_gps_47
    buffer_load_dwordx4 v[204:207], v17, s[48:51], s57 offen offset:0 sc1
L_gps_47:
    s_add_u32 s57, s57, 1024
    s_bitcmp1_b32 s86, 7
    s_cbranch_scc0 L_gps_48
    buffer_load_dwordx4 v[208:211], v17, s[48:51], s57 offen offset:0 sc1
L_gps_48:
    s_waitcnt vmcnt(0)
    s_bitcmp1_b32 s86, 0
    s_cbranch_scc0 L_gpc_49
    v_xor_b32 v180, v180, v245
    v_xor_b32 v181, v181, v245
    v_xor_b32 v182, v182, v245
    v_xor_b32 v183, v183, v245
    v_or3_b32 v8, v180, v181, v182
    v_or_b32 v8, v8, v183
    v_and_b32 v8, 7, v8
    v_cmp_ne_u32 vcc, 0, v8
    s_cbranch_vccnz L_gpc_49
    s_bitset0_b32 s86, 0
L_gpc_49:
    s_bitcmp1_b32 s86, 1
    s_cbranch_scc0 L_gpc_50
    v_xor_b32 v184, v184, v245
    v_xor_b32 v185, v185, v245
    v_xor_b32 v186, v186, v245
    v_xor_b32 v187, v187, v245
    v_or3_b32 v8, v184, v185, v186
    v_or_b32 v8, v8, v187
    v_and_b32 v8, 7, v8
    v_cmp_ne_u32 vcc, 0, v8
    s_cbranch_vccnz L_gpc_50
    s_bitset0_b32 s86, 1
L_gpc_50:
    s_bitcmp1_b32 s86, 2
    s_cbranch_scc0 L_gpc_51
    v_xor_b32 v188, v188, v245
    v_xor_b32 v189, v189, v245
    v_xor_b32 v190, v190, v245
    v_xor_b32 v191, v191, v245
    v_or3_b32 v8, v188, v189, v190
    v_or_b32 v8, v8, v191
    v_and_b32 v8, 7, v8
    v_cmp_ne_u32 vcc, 0, v8
    s_cbranch_vccnz L_gpc_51
    s_bitset0_b32 s86, 2
L_gpc_51:
    s_bitcmp1_b32 s86, 3
    s_cbranch_scc0 L_gpc_52
    v_xor_b32 v192, v192, v245
    v_xor_b32 v193, v193, v245
    v_xor_b32 v194, v194, v245
    v_xor_b32 v195, v195, v245
    v_or3_b32 v8, v192, v193, v194
    v_or_b32 v8, v8, v195
    v_and_b32 v8, 7, v8
    v_cmp_ne_u32 vcc, 0, v8
    s_cbranch_vccnz L_gpc_52
    s_bitset0_b32 s86, 3
L_gpc_52:
    s_bitcmp1_b32 s86, 4
    s_cbranch_scc0 L_gpc_53
    v_xor_b32 v196, v196, v245
    v_xor_b32 v197, v197, v245
    v_xor_b32 v198, v198, v245
    v_xor_b32 v199, v199, v245
    v_or3_b32 v8, v196, v197, v198
    v_or_b32 v8, v8, v199
    v_and_b32 v8, 7, v8
    v_cmp_ne_u32 vcc, 0, v8
    s_cbranch_vccnz L_gpc_53
    s_bitset0_b32 s86, 4
L_gpc_53:
    s_bitcmp1_b32 s86, 5
    s_cbranch_scc0 L_gpc_54
    v_xor_b32 v200, v200, v245
    v_xor_b32 v201, v201, v245
    v_xor_b32 v202, v202, v245
    v_xor_b32 v203, v203, v245
    v_or3_b32 v8, v200, v201, v202
    v_or_b32 v8, v8, v203
    v_and_b32 v8, 7, v8
    v_cmp_ne_u32 vcc, 0, v8
    s_cbranch_vccnz L_gpc_54
    s_bitset0_b32 s86, 5
L_gpc_54:
    s_bitcmp1_b32 s86, 6
    s_cbranch_scc0 L_gpc_55
    v_xor_b32 v204, v204, v245
    v_xor_b32 v205, v205, v245
    v_xor_b32 v206, v206, v245
    v_xor_b32 v207, v207, v245
    v_or3_b32 v8, v204, v205, v206
    v_or_b32 v8, v8, v207
    v_and_b32 v8, 7, v8
    v_cmp_ne_u32 vcc, 0, v8
    s_cbranch_vccnz L_gpc_55
    s_bitset0_b32 s86, 6
L_gpc_55:
    s_bitcmp1_b32 s86, 7
    s_cbranch_scc0 L_gpc_56
    v_xor_b32 v208, v208, v245
    v_xor_b32 v209, v209, v245
    v_xor_b32 v210, v210, v245
    v_xor_b32 v211, v211, v245
    v_or3_b32 v8, v208, v209, v210
    v_or_b32 v8, v8, v211
    v_and_b32 v8, 7, v8
    v_cmp_ne_u32 vcc, 0, v8
    s_cbranch_vccnz L_gpc_56
    s_bitset0_b32 s86, 7
L_gpc_56:
    s_cmp_eq_u32 s86, 0
    s_cbranch_scc1 L_gpd_40
    s_sub_u32 s62, s62, 1
    s_cbranch_scc1 L_gpd_40
    s_sleep 32
    s_branch L_gp_39
L_gpd_40:
    v_add_f32 v180, v180, v184
    v_add_f32 v181, v181, v185
    v_add_f32 v182, v182, v186
    v_add_f32 v183, v183, v187
    v_add_f32 v180, v180, v188
    v_add_f32 v181, v181, v189
    v_add_f32 v182, v182, v190
    v_add_f32 v183, v183, v191
    v_add_f32 v180, v180, v192
    v_add_f32 v181, v181, v193
    v_add_f32 v182, v182, v194
    v_add_f32 v183, v183, v195
    v_add_f32 v180, v180, v196
    v_add_f32 v181, v181, v197
    v_add_f32 v182, v182, v198
    v_add_f32 v183, v183, v199
    v_add_f32 v180, v180, v200
    v_add_f32 v181, v181, v201
    v_add_f32 v182, v182, v202
    v_add_f32 v183, v183, v203
    v_add_f32 v180, v180, v204
    v_add_f32 v181, v181, v205
    v_add_f32 v182, v182, v206
    v_add_f32 v183, v183, v207
    v_add_f32 v180, v180, v208
    v_add_f32 v181, v181, v209
    v_add_f32 v182, v182, v210
    v_add_f32 v183, v183, v211
    v_cvt_pk_bf16_f32 v180, v180, v180
    v_cvt_pk_bf16_f32 v181, v181, v181
    v_cvt_pk_bf16_f32 v182, v182, v182
    v_cvt_pk_bf16_f32 v183, v183, v183
    v_and_b32 v180, 0xffff0000, v180
    v_and_b32 v181, 0xffff0000, v181
    v_and_b32 v182, 0xffff0000, v182
    v_and_b32 v183, 0xffff0000, v183
    v_mov_b32 v184, v180
    v_mov_b32 v185, v181
    v_mov_b32 v186, v182
    v_mov_b32 v187, v183
    v_permlane32_swap_b32 v180, v184
    v_permlane32_swap_b32 v181, v185
    v_permlane32_swap_b32 v182, v186
    v_permlane32_swap_b32 v183, v187
    s_mov_b32 s56, 0xbdd2d3e8
    v_mov_b32 v9, 0xc0135761
    v_mul_f32 v188, v180, v180
    v_mul_f32 v189, v181, v181
    v_mul_f32 v190, v182, v182
    v_mul_f32 v191, v183, v183
    v_fma_f32 v188, v188, s56, v9
    v_fma_f32 v189, v189, s56, v9
    v_fma_f32 v190, v190, s56, v9
    v_fma_f32 v191, v191, s56, v9
    v_mul_f32 v188, v188, v180
    v_mul_f32 v189, v189, v181
    v_mul_f32 v190, v190, v182
    v_mul_f32 v191, v191, v183
    v_exp_f32 v188, v188
    v_exp_f32 v189, v189
    v_exp_f32 v190, v190
    v_exp_f32 v191, v191
    v_add_f32 v188, 1.0, v188
    v_add_f32 v189, 1.0, v189
    v_add_f32 v190, 1.0, v190
    v_add_f32 v191, 1.0, v191
    v_rcp_f32 v188, v188
    v_rcp_f32 v189, v189
    v_rcp_f32 v190, v190
    v_rcp_f32 v191, v191
    v_mul_f32 v180, v180, v188
    v_mul_f32 v181, v181, v189
    v_mul_f32 v182, v182, v190
    v_mul_f32 v183, v183, v191
    v_cvt_pk_bf16_f32 v180, v180, v180
    v_cvt_pk_bf16_f32 v181, v181, v181
    v_cvt_pk_bf16_f32 v182, v182, v182
    v_cvt_pk_bf16_f32 v183, v183, v183
    v_and_b32 v180, 0xffff0000, v180
    v_and_b32 v181, 0xffff0000, v181
    v_and_b32 v182, 0xffff0000, v182
    v_and_b32 v183, 0xffff0000, v183
    v_mul_f32 v180, v180, v184
    v_mul_f32 v181, v181, v185
    v_mul_f32 v182, v182, v186
    v_mul_f32 v183, v183, v187
    v_cvt_pk_bf16_f32 v180, v180, v180
    v_cvt_pk_bf16_f32 v181, v181, v181
    v_cvt_pk_bf16_f32 v182, v182, v182
    v_cvt_pk_bf16_f32 v183, v183, v183
    v_lshrrev_b32 v8, 3, v2
    v_lshlrev_b32 v17, 8, v8
    v_and_b32 v8, 1, v3
    v_lshl_add_u32 v17, v8, 7, v17
    v_and_b32 v8, 7, v2
    v_lshl_add_u32 v17, v8, 2, v17
    ds_write_b32 v17, v180 offset:7168
    ds_write_b32 v17, v181 offset:7200
    ds_write_b32 v17, v182 offset:7232
    ds_write_b32 v17, v183 offset:7264
    v_mov_b32 v8, 1
    s_waitcnt lgkmcnt(0)
    ds_read_b128 v[36:39], v11 offset:7168
    ds_read_b128 v[40:43], v11 offset:7184
    ds_read_b128 v[44:47], v11 offset:7200
    ds_read_b128 v[48:51], v11 offset:7216
    s_waitcnt lgkmcnt(0)
    v_and_b32 v28, v36, v4
    v_and_b32 v29, v36, v5
    v_and_b32 v30, v36, v6
    v_and_b32 v31, v36, v7
    v_and_b32 v32, v37, v4
    v_and_b32 v33, v37, v5
    v_and_b32 v34, v37, v6
    v_and_b32 v35, v37, v7
    v_mfma_f32_16x16x32_bf16 v[24:27], v[116:119], v[28:31], 0
    v_and_b32 v28, v38, v4
    v_and_b32 v29, v38, v5
    v_and_b32 v30, v38, v6
    v_and_b32 v31, v38, v7
    v_mfma_f32_16x16x32_bf16 v[24:27], v[120:123], v[32:35], v[24:27]
    v_and_b32 v32, v39, v4
    v_and_b32 v33, v39, v5
    v_and_b32 v34, v39, v6
    v_and_b32 v35, v39, v7
    v_mfma_f32_16x16x32_bf16 v[24:27], v[124:127], v[28:31], v[24:27]
    v_and_b32 v28, v40, v4
    v_and_b32 v29, v40, v5
    v_and_b32 v30, v40, v6
    v_and_b32 v31, v40, v7
    v_mfma_f32_16x16x32_bf16 v[24:27], v[128:131], v[32:35], v[24:27]
    v_and_b32 v32, v41, v4
    v_and_b32 v33, v41, v5
    v_and_b32 v34, v41, v6
    v_and_b32 v35, v41, v7
    v_mfma_f32_16x16x32_bf16 v[24:27], v[132:135], v[28:31], v[24:27]
    v_and_b32 v28, v42, v4
    v_and_b32 v29, v42, v5
    v_and_b32 v30, v42, v6
    v_and_b32 v31, v42, v7
    v_mfma_f32_16x16x32_bf16 v[24:27], v[136:139], v[32:35], v[24:27]
    v_and_b32 v32, v43, v4
    v_and_b32 v33, v43, v5
    v_and_b32 v34, v43, v6
    v_and_b32 v35, v43, v7
    v_mfma_f32_16x16x32_bf16 v[24:27], v[140:143], v[28:31], v[24:27]
    v_and_b32 v28, v44, v4
    v_and_b32 v29, v44, v5
    v_and_b32 v30, v44, v6
    v_and_b32 v31, v44, v7
    v_mfma_f32_16x16x32_bf16 v[24:27], v[144:147], v[32:35], v[24:27]
    v_and_b32 v32, v45, v4
    v_and_b32 v33, v45, v5
    v_and_b32 v34, v45, v6
    v_and_b32 v35, v45, v7
    v_mfma_f32_16x16x32_bf16 v[24:27], v[148:151], v[28:31], v[24:27]
    v_and_b32 v28, v46, v4
    v_and_b32 v29, v46, v5
    v_and_b32 v30, v46, v6
    v_and_b32 v31, v46, v7
    v_mfma_f32_16x16x32_bf16 v[24:27], v[152:155], v[32:35], v[24:27]
    v_and_b32 v32, v47, v4
    v_and_b32 v33, v47, v5
    v_and_b32 v34, v47, v6
    v_and_b32 v35, v47, v7
    v_mfma_f32_16x16x32_bf16 v[24:27], v[156:159], v[28:31], v[24:27]
    v_and_b32 v28, v48, v4
    v_and_b32 v29, v48, v5
    v_and_b32 v30, v48, v6
    v_and_b32 v31, v48, v7
    v_mfma_f32_16x16x32_bf16 v[24:27], v[160:163], v[32:35], v[24:27]
    v_and_b32 v32, v49, v4
    v_and_b32 v33, v49, v5
    v_and_b32 v34, v49, v6
    v_and_b32 v35, v49, v7
    v_mfma_f32_16x16x32_bf16 v[24:27], v[164:167], v[28:31], v[24:27]
    v_and_b32 v28, v50, v4
    v_and_b32 v29, v50, v5
    v_and_b32 v30, v50, v6
    v_and_b32 v31, v50, v7
    v_mfma_f32_16x16x32_bf16 v[24:27], v[168:171], v[32:35], v[24:27]
    v_and_b32 v32, v51, v4
    v_and_b32 v33, v51, v5
    v_and_b32 v34, v51, v6
    v_and_b32 v35, v51, v7
    v_mfma_f32_16x16x32_bf16 v[24:27], v[172:175], v[28:31], v[24:27]
    s_nop 0
    v_mfma_f32_16x16x32_bf16 v[24:27], v[176:179], v[32:35], v[24:27]
    s_lshl_b32 s56, s69, 10
    s_add_u32 s56, s56, 786432
    s_nop 5
    v_bfi_b32 v24, 7, v245, v24
    v_bfi_b32 v25, 7, v245, v25
    v_bfi_b32 v26, 7, v245, v26
    v_bfi_b32 v27, 7, v245, v27
    buffer_store_dwordx4 v[24:27], v14, s[48:51], s56 offen offset:0 sc1
L_A1_noffn2:
    v_and_b32 v8, 31, v1
    v_lshlrev_b32 v16, 4, v8
    v_mov_b32 v15, 0
    v_and_b32 v9, 7, v1
    v_lshlrev_b32 v9, 4, v9
    v_add_u32 v9, 512, v9
    v_cmp_gt_u32 vcc, 32, v1
    s_nop 0
    s_mov_b64 s[64:65], vcc
    s_lshl_b32 s57, s29, 8
    v_lshlrev_b32 v18, 4, v2
    v_add_u32 v18, s57, v18
    v_cndmask_b32 v18, v9, v18, vcc
    v_and_b32 v8, 1, v3
    v_lshl_add_u32 v18, v8, 12, v18
    v_lshlrev_b32 v19, 8, v8
    v_bfe_u32 v8, v1, 3, 1
    v_lshl_add_u32 v19, v8, 7, v19
    v_and_b32 v8, 7, v1
    v_lshl_add_u32 v19, v8, 2, v19
    v_lshrrev_b32 v8, 3, v1
    v_lshlrev_b32 v17, 13, v8
    v_and_b32 v8, 7, v1
    v_lshl_add_u32 v17, v8, 4, v17
    s_lshl_b32 s58, s30, 16
    s_lshl_b32 s59, s28, 8
    s_add_u32 s58, s58, s59
    s_lshl_b32 s59, s29, 7
    s_add_u32 s58, s58, s59
    s_add_u32 s58, s58, 0x100000
    s_lshl_b32 s56, s28, 13
    s_add_u32 s56, s56, 524288
    s_mov_b32 s95, 1
    s_branch L_A1_dry0
L_A1_real:
    s_mov_b32 s95, 0
L_A1_wait:
    s_sleep 4
    ds_read_b32 v8, v15 offset:6468
    s_waitcnt lgkmcnt(0)
    v_cmp_eq_u32 vcc, 0, v8
    s_cbranch_vccnz L_A1_wait
    buffer_load_dwordx4 v[52:55], v246, s[40:43], s68 offen offset:0 nt
    buffer_load_dwordx4 v[56:59], v246, s[40:43], s68 offen offset:1024 nt
    buffer_load_dwordx4 v[60:63], v246, s[40:43], s68 offen offset:2048 nt
    buffer_load_dwordx4 v[64:67], v246, s[40:43], s68 offen offset:3072 nt
    s_add_u32 s68, s68, 4096
    buffer_load_dwordx4 v[68:71], v246, s[40:43], s68 offen offset:0 nt
    buffer_load_dwordx4 v[72:75], v246, s[40:43], s68 offen offset:1024 nt
    buffer_load_dwordx4 v[76:79], v246, s[40:43], s68 offen offset:2048 nt
    buffer_load_dwordx4 v[80:83], v246, s[40:43], s68 offen offset:3072 nt
    s_add_u32 s68, s68, 4096
    buffer_load_dwordx4 v[84:87], v246, s[40:43], s68 offen offset:0 nt
    buffer_load_dwordx4 v[88:91], v246, s[40:43], s68 offen offset:1024 nt
    buffer_load_dwordx4 v[92:95], v246, s[40:43], s68 offen offset:2048 nt
    buffer_load_dwordx4 v[96:99], v246, s[40:43], s68 offen offset:3072 nt
    s_add_u32 s68, s68, 4096
    buffer_load_dwordx4 v[100:103], v246, s[40:43], s68 offen offset:0 nt
    buffer_load_dwordx4 v[104:107], v246, s[40:43], s68 offen offset:1024 nt
    buffer_load_dwordx4 v[108:111], v246, s[40:43], s68 offen offset:2048 nt
    buffer_load_dwordx4 v[112:115], v246, s[40:43], s68 offen offset:3072 nt
    s_setprio 3
    s_barrier
L_A1_dry0:
    ds_read_b128 v[180:183], v15 offset:6400
    ds_read_b128 v[184:187], v15 offset:6416
    ds_read_b128 v[116:119], v16 offset:4352
    ds_read_b128 v[120:123], v16 offset:4864
    ds_read_b128 v[124:127], v16 offset:5376
    ds_read_b128 v[128:131], v16 offset:5888
    s_waitcnt lgkmcnt(4)
    v_max_f32 v12, v180, v182
    v_max3_f32 v12, v12, v184, v186
    v_sub_f32 v188, v180, v12
    v_sub_f32 v189, v182, v12
    v_sub_f32 v190, v184, v12
    v_sub_f32 v191, v186, v12
    v_mul_f32 v188, s33, v188
    v_mul_f32 v189, s33, v189
    v_mul_f32 v190, s33, v190
    v_mul_f32 v191, s33, v191
    v_exp_f32 v188, v188
    v_exp_f32 v189, v189
    v_exp_f32 v190, v190
    v_exp_f32 v191, v191
    v_mul_f32 v13, v188, v181
    v_fmac_f32 v13, v189, v183
    v_fmac_f32 v13, v190, v185
    v_fmac_f32 v13, v191, v187
    s_waitcnt lgkmcnt(0)
    v_mul_f32 v116, v188, v116
    v_mul_f32 v117, v188, v117
    v_mul_f32 v118, v188, v118
    v_mul_f32 v119, v188, v119
    v_fmac_f32 v116, v189, v120
    v_fmac_f32 v117, v189, v121
    v_fmac_f32 v118, v189, v122
    v_fmac_f32 v119, v189, v123
    v_fmac_f32 v116, v190, v124
    v_fmac_f32 v117, v190, v125
    v_fmac_f32 v118, v190, v126
    v_fmac_f32 v119, v190, v127
    v_fmac_f32 v116, v191, v128
    v_fmac_f32 v117, v191, v129
    v_fmac_f32 v118, v191, v130
    v_fmac_f32 v119, v191, v131
    v_cndmask_b32 v116, v12, v116, s[64:65]
    v_cndmask_b32 v117, v13, v117, s[64:65]
    v_cndmask_b32 v118, v12, v118, s[64:65]
    v_cndmask_b32 v119, v13, v119, s[64:65]
    s_cmp_lg_u32 s95, 0
    s_cbranch_scc1 L_A1_dry1
    s_mov_b32 exec_hi, 0xff
    v_bfi_b32 v116, 7, v245, v116
    v_bfi_b32 v117, 7, v245, v117
    v_bfi_b32 v118, 7, v245, v118
    v_bfi_b32 v119, 7, v245, v119
    buffer_store_dwordx4 v[116:119], v14, s[48:51], s63 offen offset:0 sc1
    s_mov_b64 exec, -1
    s_mov_b32 s62, 0x40000
    s_mov_b32 s86, 15
    s_add_u32 s87, s56, 0
    s_add_u32 s88, s56, 1024
    s_add_u32 s89, s56, 2048
    s_add_u32 s90, s56, 3072
    buffer_load_dwordx4 v[196:199], v18, s[48:51], s87 offen offset:0 sc1
    buffer_load_dwordx4 v[200:203], v18, s[48:51], s88 offen offset:0 sc1
    buffer_load_dwordx4 v[204:207], v18, s[48:51], s89 offen offset:0 sc1
    buffer_load_dwordx4 v[208:211], v18, s[48:51], s90 offen offset:0 sc1
    s_sleep 8
L_op_57:
    buffer_load_dwordx4 v[212:215], v18, s[48:51], s87 offen offset:0 sc1
    buffer_load_dwordx4 v[216:219], v18, s[48:51], s88 offen offset:0 sc1
    buffer_load_dwordx4 v[220:223], v18, s[48:51], s89 offen offset:0 sc1
    buffer_load_dwordx4 v[224:227], v18, s[48:51], s90 offen offset:0 sc1
    s_waitcnt vmcnt(4)
    s_bitcmp1_b32 s86, 0
    s_cbranch_scc0 L_opc_59
    v_xor_b32 v132, v196, v245
    v_xor_b32 v133, v197, v245
    v_xor_b32 v134, v198, v245
    v_xor_b32 v135, v199, v245
    v_or3_b32 v8, v132, v133, v134
    v_or_b32 v8, v8, v135
    v_and_b32 v8, 7, v8
    v_cmp_ne_u32 vcc, 0, v8
    s_cbranch_vccnz L_opc_59
    s_bitset0_b32 s86, 0
    s_mov_b32 s87, 0x40000000
L_opc_59:
    s_bitcmp1_b32 s86, 1
    s_cbranch_scc0 L_opc_60
    v_xor_b32 v136, v200, v245
    v_xor_b32 v137, v201, v245
    v_xor_b32 v138, v202, v245
    v_xor_b32 v139, v203, v245
    v_or3_b32 v8, v136, v137, v138
    v_or_b32 v8, v8, v139
    v_and_b32 v8, 7, v8
    v_cmp_ne_u32 vcc, 0, v8
    s_cbranch_vccnz L_opc_60
    s_bitset0_b32 s86, 1
    s_mov_b32 s88, 0x40000000
L_opc_60:
    s_bitcmp1_b32 s86, 2
    s_cbranch_scc0 L_opc_61
    v_xor_b32 v140, v204, v245
    v_xor_b32 v141, v205, v245
    v_xor_b32 v142, v206, v245
    v_xor_b32 v143, v207, v245
    v_or3_b32 v8, v140, v141, v142
    v_or_b32 v8, v8, v143
    v_and_b32 v8, 7, v8
    v_cmp_ne_u32 vcc, 0, v8
    s_cbranch_vccnz L_opc_61
    s_bitset0_b32 s86, 2
    s_mov_b32 s89, 0x40000000
L_opc_61:
    s_bitcmp1_b32 s86, 3
    s_cbranch_scc0 L_opc_62
    v_xor_b32 v144, v208, v245
    v_xor_b32 v145, v209, v245
    v_xor_b32 v146, v210, v245
    v_xor_b32 v147, v211, v245
    v_or3_b32 v8, v144, v145, v146
    v_or_b32 v8, v8, v147
    v_and_b32 v8, 7, v8
    v_cmp_ne_u32 vcc, 0, v8
    s_cbranch_vccnz L_opc_62
    s_bitset0_b32 s86, 3
    s_mov_b32 s90, 0x40000000
L_opc_62:
    s_cmp_eq_u32 s86, 0
    s_cbranch_scc1 L_opd_58
    buffer_load_dwordx4 v[196:199], v18, s[48:51], s87 offen offset:0 sc1
    buffer_load_dwordx4 v[200:203], v18, s[48:51], s88 offen offset:0 sc1
    buffer_load_dwordx4 v[204:207], v18, s[48:51], s89 offen offset:0 sc1
    buffer_load_dwordx4 v[208:211], v18, s[48:51], s90 offen offset:0 sc1
    s_waitcnt vmcnt(4)
    s_bitcmp1_b32 s86, 0
    s_cbranch_scc0 L_opc_63
    v_xor_b32 v132, v212, v245
    v_xor_b32 v133, v213, v245
    v_xor_b32 v134, v214, v245
    v_xor_b32 v135, v215, v245
    v_or3_b32 v8, v132, v133, v134
    v_or_b32 v8, v8, v135
    v_and_b32 v8, 7, v8
    v_cmp_ne_u32 vcc, 0, v8
    s_cbranch_vccnz L_opc_63
    s_bitset0_b32 s86, 0
    s_mov_b32 s87, 0x40000000
L_opc_63:
    s_bitcmp1_b32 s86, 1
    s_cbranch_scc0 L_opc_64
    v_xor_b32 v136, v216, v245
    v_xor_b32 v137, v217, v245
    v_xor_b32 v138, v218, v245
    v_xor_b32 v139, v219, v245
    v_or3_b32 v8, v136, v137, v138
    v_or_b32 v8, v8, v139
    v_and_b32 v8, 7, v8
    v_cmp_ne_u32 vcc, 0, v8
    s_cbranch_vccnz L_opc_64
    s_bitset0_b32 s86, 1
    s_mov_b32 s88, 0x40000000
L_opc_64:
    s_bitcmp1_b32 s86, 2
    s_cbranch_scc0 L_opc_65
    v_xor_b32 v140, v220, v245
    v_xor_b32 v141, v221, v245
    v_xor_b32 v142, v222, v245
    v_xor_b32 v143, v223, v245
    v_or3_b32 v8, v140, v141, v142
    v_or_b32 v8, v8, v143
    v_and_b32 v8, 7, v8
    v_cmp_ne_u32 vcc, 0, v8
    s_cbranch_vccnz L_opc_65
    s_bitset0_b32 s86, 2
    s_mov_b32 s89, 0x40000000
L_opc_65:
    s_bitcmp1_b32 s86, 3
    s_cbranch_scc0 L_opc_66
    v_xor_b32 v144, v224, v245
    v_xor_b32 v145, v225, v245
    v_xor_b32 v146, v226, v245
    v_xor_b32 v147, v227, v245
    v_or3_b32 v8, v144, v145, v146
    v_or_b32 v8, v8, v147
    v_and_b32 v8, 7, v8
    v_cmp_ne_u32 vcc, 0, v8
    s_cbranch_vccnz L_opc_66
    s_bitset0_b32 s86, 3
    s_mov_b32 s90, 0x40000000
L_opc_66:
    s_cmp_eq_u32 s86, 0
    s_cbranch_scc1 L_opd_58
    s_sub_u32 s62, s62, 1
    s_cbranch_scc0 L_op_57
L_opd_58:
L_A1_dry1:
    v_mov_b32 v180, v132
    v_mov_b32 v181, v133
    v_mov_b32 v182, v136
    v_mov_b32 v183, v137
    v_mov_b32 v184, v140
    v_mov_b32 v185, v141
    v_mov_b32 v186, v144
    v_mov_b32 v187, v145
    v_permlane32_swap_b32 v132, v180
    v_permlane32_swap_b32 v133, v181
    v_permlane32_swap_b32 v136, v182
    v_permlane32_swap_b32 v137, v183
    v_permlane32_swap_b32 v140, v184
    v_permlane32_swap_b32 v141, v185
    v_permlane32_swap_b32 v144, v186
    v_permlane32_swap_b32 v145, v187
    v_max_f32 v12, v180, v182
    v_max3_f32 v12, v12, v184, v186
    v_sub_f32 v188, v180, v12
    v_sub_f32 v189, v182, v12
    v_sub_f32 v190, v184, v12
    v_sub_f32 v191, v186, v12
    v_mul_f32 v188, s33, v188
    v_mul_f32 v189, s33, v189
    v_mul_f32 v190, s33, v190
    v_mul_f32 v191, s33, v191
    v_exp_f32 v188, v188
    v_exp_f32 v189, v189
    v_exp_f32 v190, v190
    v_exp_f32 v191, v191
    v_mul_f32 v13, v188, v181
    v_fmac_f32 v13, v189, v183
    v_fmac_f32 v13, v190, v185
    v_fmac_f32 v13, v191, v187
    v_rcp_f32 v13, v13
    v_mul_f32 v132, v188, v132
    v_mul_f32 v133, v188, v133
    v_mul_f32 v134, v188, v134
    v_mul_f32 v135, v188, v135
    v_fmac_f32 v132, v189, v136
    v_fmac_f32 v133, v189, v137
    v_fmac_f32 v134, v189, v138
    v_fmac_f32 v135, v189, v139
    v_fmac_f32 v132, v190, v140
    v_fmac_f32 v133, v190, v141
    v_fmac_f32 v134, v190, v142
    v_fmac_f32 v135, v190, v143
    v_fmac_f32 v132, v191, v144
    v_fmac_f32 v133, v191, v145
    v_fmac_f32 v134, v191, v146
    v_fmac_f32 v135, v191, v147
    v_mul_f32 v132, v132, v13
    v_mul_f32 v133, v133, v13
    v_mul_f32 v134, v134, v13
    v_mul_f32 v135, v135, v13
    v_cvt_pk_bf16_f32 v132, v132, v132
    v_cvt_pk_bf16_f32 v133, v133, v133
    v_cvt_pk_bf16_f32 v134, v134, v134
    v_cvt_pk_bf16_f32 v135, v135, v135
    s_mov_b64 exec, s[64:65]
    ds_write_b32 v19, v132 offset:6656
    ds_write_b32 v19, v133 offset:6688
    ds_write_b32 v19, v134 offset:6720
    ds_write_b32 v19, v135 offset:6752
    s_mov_b64 exec, -1
    s_waitcnt lgkmcnt(0)
    ds_read_b128 v[36:39], v11 offset:6656
    ds_read_b128 v[40:43], v11 offset:6672
    ds_read_b128 v[44:47], v11 offset:6688
    ds_read_b128 v[48:51], v11 offset:6704
    s_waitcnt lgkmcnt(0)
    v_and_b32 v28, v36, v4
    v_and_b32 v29, v36, v5
    v_and_b32 v30, v36, v6
    v_and_b32 v31, v36, v7
    v_and_b32 v32, v37, v4
    v_and_b32 v33, v37, v5
    v_and_b32 v34, v37, v6
    v_and_b32 v35, v37, v7
    v_mfma_f32_16x16x32_bf16 v[24:27], v[52:55], v[28:31], 0
    v_and_b32 v28, v38, v4
    v_and_b32 v29, v38, v5
    v_and_b32 v30, v38, v6
    v_and_b32 v31, v38, v7
    v_mfma_f32_16x16x32_bf16 v[24:27], v[56:59], v[32:35], v[24:27]
    v_and_b32 v32, v39, v4
    v_and_b32 v33, v39, v5
    v_and_b32 v34, v39, v6
    v_and_b32 v35, v39, v7
    v_mfma_f32_16x16x32_bf16 v[24:27], v[60:63], v[28:31], v[24:27]
    v_and_b32 v28, v40, v4
    v_and_b32 v29, v40, v5
    v_and_b32 v30, v40, v6
    v_and_b32 v31, v40, v7
    v_mfma_f32_16x16x32_bf16 v[24:27], v[64:67], v[32:35], v[24:27]
    v_and_b32 v32, v41, v4
    v_and_b32 v33, v41, v5
    v_and_b32 v34, v41, v6
    v_and_b32 v35, v41, v7
    v_mfma_f32_16x16x32_bf16 v[24:27], v[68:71], v[28:31], v[24:27]
    v_and_b32 v28, v42, v4
    v_and_b32 v29, v42, v5
    v_and_b32 v30, v42, v6
    v_and_b32 v31, v42, v7
    v_mfma_f32_16x16x32_bf16 v[24:27], v[72:75], v[32:35], v[24:27]
    v_and_b32 v32, v43, v4
    v_and_b32 v33, v43, v5
    v_and_b32 v34, v43, v6
    v_and_b32 v35, v43, v7
    v_mfma_f32_16x16x32_bf16 v[24:27], v[76:79], v[28:31], v[24:27]
    v_and_b32 v28, v44, v4
    v_and_b32 v29, v44, v5
    v_and_b32 v30, v44, v6
    v_and_b32 v31, v44, v7
    v_mfma_f32_16x16x32_bf16 v[24:27], v[80:83], v[32:35], v[24:27]
    v_and_b32 v32, v45, v4
    v_and_b32 v33, v45, v5
    v_and_b32 v34, v45, v6
    v_and_b32 v35, v45, v7
    v_mfma_f32_16x16x32_bf16 v[24:27], v[84:87], v[28:31], v[24:27]
    v_and_b32 v28, v46, v4
    v_and_b32 v29, v46, v5
    v_and_b32 v30, v46, v6
    v_and_b32 v31, v46, v7
    v_mfma_f32_16x16x32_bf16 v[24:27], v[88:91], v[32:35], v[24:27]
    v_and_b32 v32, v47, v4
    v_and_b32 v33, v47, v5
    v_and_b32 v34, v47, v6
    v_and_b32 v35, v47, v7
    v_mfma_f32_16x16x32_bf16 v[24:27], v[92:95], v[28:31], v[24:27]
    v_and_b32 v28, v48, v4
    v_and_b32 v29, v48, v5
    v_and_b32 v30, v48, v6
    v_and_b32 v31, v48, v7
    v_mfma_f32_16x16x32_bf16 v[24:27], v[96:99], v[32:35], v[24:27]
    v_and_b32 v32, v49, v4
    v_and_b32 v33, v49, v5
    v_and_b32 v34, v49, v6
    v_and_b32 v35, v49, v7
    v_mfma_f32_16x16x32_bf16 v[24:27], v[100:103], v[28:31], v[24:27]
    v_and_b32 v28, v50, v4
    v_and_b32 v29, v50, v5
    v_and_b32 v30, v50, v6
    v_and_b32 v31, v50, v7
    v_mfma_f32_16x16x32_bf16 v[24:27], v[104:107], v[32:35], v[24:27]
    v_and_b32 v32, v51, v4
    v_and_b32 v33, v51, v5
    v_and_b32 v34, v51, v6
    v_and_b32 v35, v51, v7
    v_mfma_f32_16x16x32_bf16 v[24:27], v[108:111], v[28:31], v[24:27]
    s_nop 0
    v_mfma_f32_16x16x32_bf16 v[24:27], v[112:115], v[32:35], v[24:27]
    s_cmp_lg_u32 s95, 0
    s_cbranch_scc1 L_A1_real
    s_nop 5
    v_bfi_b32 v24, 7, v245, v24
    v_bfi_b32 v25, 7, v245, v25
    v_bfi_b32 v26, 7, v245, v26
    v_bfi_b32 v27, 7, v245, v27
    buffer_store_dwordx4 v[24:27], v17, s[48:51], s58 offen offset:0 sc1
L_end:
    s_endpgm
L_codeend:
.section .rodata,"a"
.p2align 6
.amdhsa_kernel recurrent_scan__mha_block_cached__geglu_ffn__decode_kernel
  .amdhsa_next_free_vgpr 248
  .amdhsa_next_free_sgpr 102
  .amdhsa_accum_offset 248
  .amdhsa_group_segment_fixed_size 0
  .amdhsa_kernarg_size 96
  .amdhsa_user_sgpr_count 2
  .amdhsa_user_sgpr_kernarg_segment_ptr 1
  .amdhsa_system_sgpr_workgroup_id_x 1
  .amdhsa_float_denorm_mode_32 3
.end_amdhsa_kernel
```
